```python
import torch

def _softmax(x, axis=-1):
    return torch.softmax(x, dim=axis)
def _gelu(x):
    return torch.nn.functional.gelu(x, approximate="tanh")
def _silu(x):
    return torch.nn.functional.silu(x)
def _sigmoid(x):
    return torch.sigmoid(x)
def _layernorm(x, axis=-1, eps=1e-5):
    m = x.mean(dim=axis, keepdim=True)
    v = x.var(dim=axis, keepdim=True, unbiased=False)
    return (x - m) / torch.sqrt(v + eps)
def _scatter_add(tgt, idx, src, axis=0):
    return tgt.clone().index_add_(axis, idx, src)
def _segment_sum(src, seg, n):
    out = torch.zeros((n,) + src.shape[1:], dtype=src.dtype)
    return out.index_add_(0, seg, src)
def _pad(x, pw):
    flat = tuple(v for pair in reversed(pw) for v in pair)
    return torch.nn.functional.pad(x, flat)

kernel_name = 'gated_mix__grouped_kv_mqa__glu_gated_swiglu__prompt'

def setup_inputs():

    _w = (lambda a: (lambda t: t.to(torch.bfloat16) if t.is_floating_point() else t)(torch.as_tensor(a)))
    def _A_setup():
        B, S, D, H = 1, 2048, 512, 32
        Dh = D // H
        return {
            "x": _w((lambda *s: torch.randn(*s, dtype=torch.bfloat16) * 0.05)(B, S, D)),
            "wq": _w((lambda *s: torch.randn(*s, dtype=torch.bfloat16) * 0.8)(D, H * Dh)),
            "wk": _w((lambda *s: torch.randn(*s, dtype=torch.bfloat16) * 0.8)(D, Dh)),
            "wv": _w((lambda *s: torch.randn(*s, dtype=torch.bfloat16) * 0.05)(D, Dh)),
            "wo": _w((lambda *s: torch.randn(*s, dtype=torch.bfloat16) * 0.05)(H * Dh, D)),
        }
    _A_in = _A_setup()

    def _B_setup():
        B, S, D, F = 1, 2048, 512, 1376
        return {
            "x": _w((lambda *s: torch.randn(*s, dtype=torch.bfloat16) * 0.05)(B, S, D)),
            "w1": _w((lambda *s: torch.randn(*s, dtype=torch.bfloat16) * 0.8)(D, F) * (2.0 / D) ** 0.5),
            "w3": _w((lambda *s: torch.randn(*s, dtype=torch.bfloat16) * 0.8)(D, F) * (2.0 / D) ** 0.5),
            "w2": _w((lambda *s: torch.randn(*s, dtype=torch.bfloat16) * 0.8)(F, D) * (2.0 / F) ** 0.5),
        }
    _B_in = _B_setup()

    return {
        "A_x": _A_in["x"],
        "A_wq": _A_in["wq"],
        "A_wk": _A_in["wk"],
        "A_wv": _A_in["wv"],
        "A_wo": _A_in["wo"],
        "B_x": _B_in["x"],
        "B_w1": _B_in["w1"],
        "B_w3": _B_in["w3"],
        "B_w2": _B_in["w2"],
        "gate_w": _w((lambda *s: torch.randn(*s, dtype=torch.bfloat16) * 0.05)(512) * 16.0),
    }

def reference(A_x, A_wq, A_wk, A_wv, A_wo, B_x, B_w1, B_w3, B_w2, gate_w):
    def _A_ref(x, wq, wk, wv, wo):
        B, S, D = x.shape
        H = 32
        Dh = D // H
        q = (lambda x, *d: x.permute(*d))((x @ wq).reshape(B, S, H, Dh), 0, 2, 1, 3)
        k = x @ wk
        v = x @ wv
        scores = torch.einsum("bhqd,bkd->bhqk", q, k) * (Dh ** -0.5)
        p = _softmax(scores, axis=-1)
        o = torch.einsum("bhqk,bkd->bhqd", p, v)
        return (lambda x, *d: x.permute(*d))(o, 0, 2, 1, 3).reshape(B, S, H * Dh) @ wo

    def _B_ref(x, w1, w3, w2):
        gate = torch.einsum("bsd,df->bsf", x, w1)
        up = torch.einsum("bsd,df->bsf", x, w3)
        h = _silu(gate) * up
        out = torch.einsum("bsf,fd->bsd", h, w2)
        return out

    x = A_x
    g = _sigmoid((x * gate_w).sum(-1, keepdims=True))
    a = _A_ref(x, A_wq, A_wk, A_wv, A_wo)
    b = _B_ref(x, B_w1, B_w3, B_w2)
    return g * a + (1 - g) * b
```

```asm
; @launch grid=(256,1,1) block=(512,1,1) lds=163840
.amdgcn_target "amdgcn-amd-amdhsa--gfx950"
.text
.globl gated_mix__grouped_kv_mqa__glu_gated_swiglu__prompt_kernel
.p2align 8
.type gated_mix__grouped_kv_mqa__glu_gated_swiglu__prompt_kernel,@function
gated_mix__grouped_kv_mqa__glu_gated_swiglu__prompt_kernel:
    s_cmp_ge_u32 s2, 256
    s_cbranch_scc1 L_end
    s_load_dwordx16 s[4:19], s[0:1], 0
    s_load_dwordx8 s[20:27], s[0:1], 64
    s_load_dwordx2 s[28:29], s[0:1], 96
    v_lshrrev_b32 v1, 6, v0
    s_getpc_b64 s[74:75]
    s_lshr_b32 s73, s2, 3
    s_mul_i32 s73, s73, 1280
    v_mov_b32 v17, 0
    v_lshl_add_u32 v16, v0, 2, s73
    v_min_u32 v16, L_last-gated_mix__grouped_kv_mqa__glu_gated_swiglu__prompt_kernel-64, v16
    v_lshl_add_u64 v[16:17], v[16:17], 0, s[74:75]
    global_load_dword v127, v[16:17], off
    s_lshl_b32 s73, s2, 11
    v_lshl_add_u32 v126, v0, 2, s73
    v_and_b32 v0, 63, v0
    v_readfirstlane_b32 s72, v1
    s_and_b32 s68, s2, 31
    s_lshr_b32 s69, s2, 5
    s_add_u32 s70, s2, s69
    s_and_b32 s70, s70, 7
    s_and_b32 s79, s69, 3
    s_lshl_b32 s73, s72, 2
    s_lshr_b32 s73, 0xc8a94761, s73
    s_and_b32 s73, s73, 15
    s_lshl_b32 s73, s73, 3
    s_load_dwordx2 s[90:91], s[0:1], s73
    v_lshrrev_b32 v4, 3, v0
    v_lshrrev_b32 v6, 4, v0
    v_bitop3_b32 v5, v0, 7, v6 bitop3:0x6a
    v_lshlrev_b32 v5, 4, v5
    v_lshl_add_u32 v4, v4, 10, v5
    s_lshl2_add_u32 s73, s68, s79
    s_lshl_b32 s73, s73, 14
    v_add_u32 v1, s73, v4
    v_xor_b32 v2, 0x2040, v1
    v_lshrrev_b32 v5, 1, v0
    v_bitop3_b32 v5, v5, 8, v0 bitop3:0x6a
    v_lshlrev_b32 v3, 4, v5
    s_xor_b32 s73, s72, s70
    s_lshl_b32 s74, s73, 7
    s_lshl_b32 s75, s73, 11
    s_lshl2_add_u32 s76, s72, s79
    s_lshl_b32 s76, s76, 11
    s_lshl_b32 s77, s72, 11
    s_and_b32 s71, s72, 3
    s_mov_b32 s34, 2097152
    s_mov_b32 s35, 0x20000
    s_mov_b32 s62, 16384
    s_mov_b32 s63, 0x20000
    s_mov_b32 s58, 524288
    s_mov_b32 s59, 0x20000
    v_mul_u32_u24 v6, 80, v6
    v_and_b32 v6, 0x70, v6
    s_lshl_b32 s92, s71, 10
    s_lshl_b32 s73, s69, 7
    s_lshl3_add_u32 s73, s92, s73
    v_xad_u32 v37, v4, v6, s73
    s_bitcmp1_b32 s71, 0
    s_cselect_b32 s73, 0x2040, 0
    v_xor_b32 v5, s73, v1
    v_xor_b32 v45, 16384, v5
    v_xor_b32 v46, 32768, v5
    v_xor_b32 v47, 49152, v5
    s_add_u32 m0, s76, 32768
    s_cmp_lt_u32 s69, 4
    s_waitcnt lgkmcnt(0)
    s_mov_b64 s[32:33], s[4:5]
    buffer_load_dwordx4 v1, s[32:35], s74 offen lds
    s_cselect_b64 s[60:61], s[10:11], s[8:9]
    s_add_u32 m0, s76, 33792
    s_load_dword s30, s[28:29], 0
    buffer_load_dwordx4 v2, s[32:35], s74 offen lds
    s_mov_b64 s[56:57], s[6:7]
    buffer_load_dword v126, v126, s[56:59], 0 offen
    s_mov_b32 m0, s77
    s_cmp_ge_u32 s2, 32
    buffer_load_dwordx4 v3, s[60:63], s75 offen lds
    buffer_load_dwordx4 v3, s[60:63], s75 offen offset:1024 lds
    s_cbranch_scc1 L_notlb
    s_load_dword s14, s[22:23], s74
    s_load_dword s3, s[90:91], 0
L_notlb:
    s_mov_b64 s[44:45], s[28:29]
    s_mul_i32 s73, s71, 0x1400
    s_and_b32 s73, s73, 0x2400
    s_lshl_b32 s84, s79, 11
    s_or_b32 s84, s84, s73
    s_lshr_b32 s73, s71, 1
    s_xor_b32 s73, s73, s70
    s_lshl_b32 s85, s73, 7
    s_lshl_b32 s86, s70, 16
    s_mov_b32 s46, 11534336
    s_mov_b32 s47, 0x20000
    s_cmp_ge_u32 s72, 4
    s_cbranch_scc1 L_B
    v_mov_b64 v[38:39], 0
    s_and_b32 s73, s71, 1
    s_lshl_b32 s73, s73, 12
    s_add_u32 s73, s73, 32768
    v_mfma_f32_32x32x8bf16_1k v[128:143], v[38:39], v[38:39], 0
    v_mfma_f32_32x32x8bf16_1k v[144:159], v[38:39], v[38:39], 0
    v_mfma_f32_32x32x8bf16_1k v[160:175], v[38:39], v[38:39], 0
    v_mfma_f32_32x32x8bf16_1k v[176:191], v[38:39], v[38:39], 0
    v_mfma_f32_32x32x8bf16_1k v[192:207], v[38:39], v[38:39], 0
    v_mfma_f32_32x32x8bf16_1k v[208:223], v[38:39], v[38:39], 0
    v_mfma_f32_32x32x8bf16_1k v[224:239], v[38:39], v[38:39], 0
    v_mfma_f32_32x32x8bf16_1k v[240:255], v[38:39], v[38:39], 0
    v_and_b32 v32, 31, v0
    v_bfe_u32 v16, v0, 1, 3
    v_lshrrev_b32 v17, 5, v0
    v_xor_b32 v16, v16, v17
    v_lshlrev_b32 v16, 4, v16
    v_lshl_add_u32 v32, v32, 7, v16
    v_add_u32 v32, s73, v32
    v_xor_b32 v33, 32, v32
    v_xor_b32 v34, 64, v32
    v_xor_b32 v35, 96, v32
    v_and_b32 v16, 3, v0
    v_mul_u32_u24 v16, 20, v16
    v_and_b32 v17, 24, v0
    v_mul_u32_u24 v17, 10, v17
    v_and_b32 v17, 96, v17
    v_and_or_b32 v16, v16, 24, v17
    v_and_b32 v17, 0x2c, v0
    v_lshl_or_b32 v16, v17, 5, v16
    s_lshr_b32 s73, s71, 1
    s_lshl_b32 s73, s73, 6
    s_add_u32 s73, s73, 98304
    v_xor_b32 v36, s73, v16
    s_mov_b32 s96, 0xffff
    s_mov_b32 s97, 0xffff
    v_lshlrev_b32 v72, 4, v0
    s_lshl_b32 s82, s71, 15
    s_add_u32 s73, s82, 65536
    v_add_u32 v2, s73, v72
    v_and_b32 v73, 15, v0
    v_lshl_add_u32 v73, v73, 4, s73
    v_lshrrev_b32 v74, 5, v0
    v_lshl_add_u32 v3, v74, 8, v73
    v_and_b32 v73, 27, v0
    v_cmp_eq_u32 vcc, 16, v73
    s_add_u32 s73, s82, 458752
    v_mov_b32 v75, s73
    s_add_u32 m0, s92, 98304
    s_xor_b32 s89, s86, 0
    buffer_load_dwordx4 v37, s[56:59], s89 offen lds
    s_add_u32 m0, s92, 102400
    s_xor_b32 s89, s86, 32768
    buffer_load_dwordx4 v37, s[56:59], s89 offen lds
    s_add_u32 m0, s92, 114688
    s_xor_b32 s89, s86, 65536
    buffer_load_dwordx4 v37, s[56:59], s89 offen lds
    s_add_u32 m0, s92, 118784
    s_xor_b32 s89, s86, 98304
    buffer_load_dwordx4 v37, s[56:59], s89 offen lds
    s_xor_b32 m0, s84, 34816
    s_xor_b32 s87, s85, 0
    buffer_load_dwordx4 v45, s[32:35], s87 offen lds
    s_xor_b32 m0, s84, 36864
    v_mov_b32 v74, 0x3f803f80
    v_cndmask_b32 v73, 2.0, v75, vcc
    v_cndmask_b32 v56, 0, v74, vcc
    v_cndmask_b32 v57, 0, v74, vcc
    buffer_load_dwordx4 v46, s[32:35], s87 offen lds
    s_xor_b32 m0, s84, 38912
    v_cndmask_b32 v3, v73, v3, s[96:97]
    buffer_load_dwordx4 v47, s[32:35], s87 offen lds
    v_mov_b64 v[58:59], v[56:57]
    v_mov_b64 v[64:65], v[56:57]
    v_mov_b64 v[66:67], v[56:57]
    v_mov_b64 v[80:81], v[56:57]
    v_mov_b64 v[82:83], v[56:57]
    v_mov_b64 v[88:89], v[56:57]
    v_mov_b64 v[90:91], v[56:57]
    s_and_b32 s78, s68, 7
    s_lshl_b32 s60, s78, 12
    s_lshl1_add_u32 s82, s60, s82
    s_add_u32 s82, s82, 131072
    s_add_u32 s83, s82, 4096
    s_lshl_b32 s74, s71, 11
    v_add_u32 v4, s74, v72
    v_lshlrev_b32 v14, 2, v0
    s_lshl_b32 s73, s71, 8
    v_add_u32 v5, s73, v14
    v_mov_b32 v73, -1
    v_xor_b32 v6, 2048, v4
    v_xor_b32 v9, 256, v5
    v_add_u32 v40, 106496, v6
    v_xor_b32 v7, 4096, v4
    v_xor_b32 v10, 512, v5
    v_add_u32 v41, 106496, v7
    v_xor_b32 v8, 6144, v4
    v_xor_b32 v11, 768, v5
    v_add_u32 v42, 106496, v8
    ds_write2st64_b32 v5, v73, v73 offset0:97 offset1:101
    ds_write2st64_b32 v5, v73, v73 offset0:105 offset1:109
    ds_write2st64_b32 v5, v73, v73 offset0:113 offset1:117
    s_waitcnt vmcnt(7)
    s_barrier
    s_add_u32 m0, s92, 131072
    s_xor_b32 s89, s86, 131072
    buffer_load_dwordx4 v37, s[56:59], s89 offen lds
    v_add_u32 v43, 106496, v4
    v_mov_b32 v1, 0xdddddddd
    s_lshl2_add_u32 s81, s68, s71
    s_lshl3_add_u32 s81, s81, s69
    s_lshl_b32 s81, s81, 11
    s_add_u32 s81, s81, 589824
    s_add_u32 m0, s92, 135168
    s_xor_b32 s89, s86, 163840
    buffer_load_dwordx4 v37, s[56:59], s89 offen lds
    s_sub_u32 s81, s81, s74
    s_lshl_b32 s73, s71, 4
    s_lshl_b64 s[94:95], 0xffff, s73
    s_xor_b32 s61, s60, 4096
    s_add_u32 m0, s92, 147456
    s_xor_b32 s89, s86, 196608
    buffer_load_dwordx4 v37, s[56:59], s89 offen lds
    s_xor_b32 s62, s60, 8192
    s_xor_b32 s63, s60, 12288
    s_xor_b32 s64, s60, 16384
    s_xor_b32 s65, s60, 20480
    s_add_u32 m0, s92, 151552
    s_xor_b32 s89, s86, 229376
    buffer_load_dwordx4 v37, s[56:59], s89 offen lds
    s_xor_b32 s66, s60, 24576
    s_xor_b32 s67, s60, 28672
    s_lshl_b32 s90, s71, 10
    s_add_u32 s90, s90, 4096
    s_lshl_b32 s78, s78, 7
    s_add_u32 s80, s90, s78
    s_xor_b32 m0, s84, 51200
    s_xor_b32 s87, s85, 256
    buffer_load_dwordx4 v45, s[32:35], s87 offen lds
    s_lshl_b32 s91, s68, 7
    s_add_u32 s91, s91, 4096
    s_getreg_b32 s37, hwreg(HW_REG_XCC_ID, 0, 4)
    s_and_b32 s73, s71, 1
    s_lshl_b32 s73, s73, 7
    v_and_b32 v12, 31, v0
    v_lshl_add_u32 v12, v12, 2, s73
    s_xor_b32 m0, s84, 53248
    v_lshrrev_b32 v13, 3, v0
    v_mul_u32_u24 v13, 64, v13
    v_lshl_add_u32 v13, v0, 3, v13
    buffer_load_dwordx4 v46, s[32:35], s87 offen lds
    s_xor_b32 m0, s84, 55296
    s_nop 0
    buffer_load_dwordx4 v47, s[32:35], s87 offen lds
    s_waitcnt lgkmcnt(0)
    s_mul_i32 s30, s30, 0x9E3779B1
    s_add_u32 s30, s30, 0x7F4A7C15
    s_mov_b32 s36, s30
    s_waitcnt vmcnt(7)
    s_barrier
    ds_read_b128 v[96:99], v32 offset:0
    ds_read_b64_tr_b16 v[100:101], v36 offset:0
    ds_read_b64_tr_b16 v[102:103], v36 offset:512
    ds_read_b128 v[104:107], v33 offset:0
    ds_read_b64_tr_b16 v[108:109], v36 offset:2048
    ds_read_b64_tr_b16 v[110:111], v36 offset:2560
    ds_read_b128 v[112:115], v34 offset:0
    ds_read_b64_tr_b16 v[116:117], v36 offset:4096
    ds_read_b64_tr_b16 v[118:119], v36 offset:4608
    ds_read_b128 v[120:123], v35 offset:0
    ds_read_b64_tr_b16 v[124:125], v36 offset:6144
    ds_read_b64_tr_b16 v[126:127], v36 offset:6656
    s_waitcnt lgkmcnt(9)
    v_mfma_f32_32x32x16_bf16 v[16:31], v[100:103], v[96:99], 0
    ds_read_b128 v[96:99], v32 offset:8192
    ds_read_b64_tr_b16 v[100:101], v36 offset:16384
    ds_read_b64_tr_b16 v[102:103], v36 offset:16896
    s_waitcnt lgkmcnt(9)
    v_mfma_f32_32x32x16_bf16 v[16:31], v[108:111], v[104:107], v[16:31]
    ds_read_b128 v[104:107], v33 offset:8192
    ds_read_b64_tr_b16 v[108:109], v36 offset:18432
    ds_read_b64_tr_b16 v[110:111], v36 offset:18944
    s_waitcnt lgkmcnt(9)
    v_mfma_f32_32x32x16_bf16 v[16:31], v[116:119], v[112:115], v[16:31]
    ds_read_b128 v[112:115], v34 offset:8192
    ds_read_b64_tr_b16 v[116:117], v36 offset:20480
    ds_read_b64_tr_b16 v[118:119], v36 offset:20992
    s_waitcnt lgkmcnt(9)
    v_mfma_f32_32x32x16_bf16 v[16:31], v[124:127], v[120:123], v[16:31]
    ds_read_b128 v[120:123], v35 offset:8192
    ds_read_b64_tr_b16 v[124:125], v36 offset:22528
    ds_read_b64_tr_b16 v[126:127], v36 offset:23040
    s_waitcnt lgkmcnt(9)
    v_mfma_f32_32x32x16_bf16 v[16:31], v[100:103], v[96:99], v[16:31]
    s_waitcnt vmcnt(0)
    s_barrier
    ds_read_b128 v[96:99], v32 offset:16384
    ds_read_b64_tr_b16 v[100:101], v36 offset:32768
    ds_read_b64_tr_b16 v[102:103], v36 offset:33280
    s_waitcnt lgkmcnt(9)
    v_mfma_f32_32x32x16_bf16 v[16:31], v[108:111], v[104:107], v[16:31]
    ds_read_b128 v[104:107], v33 offset:16384
    ds_read_b64_tr_b16 v[108:109], v36 offset:34816
    ds_read_b64_tr_b16 v[110:111], v36 offset:35328
    s_waitcnt lgkmcnt(9)
    v_mfma_f32_32x32x16_bf16 v[16:31], v[116:119], v[112:115], v[16:31]
    ds_read_b128 v[112:115], v34 offset:16384
    ds_read_b64_tr_b16 v[116:117], v36 offset:36864
    ds_read_b64_tr_b16 v[118:119], v36 offset:37376
    s_waitcnt lgkmcnt(9)
    v_mfma_f32_32x32x16_bf16 v[16:31], v[124:127], v[120:123], v[16:31]
    ds_read_b128 v[120:123], v35 offset:16384
    ds_read_b64_tr_b16 v[124:125], v36 offset:38912
    ds_read_b64_tr_b16 v[126:127], v36 offset:39424
    s_waitcnt lgkmcnt(9)
    v_mfma_f32_32x32x16_bf16 v[16:31], v[100:103], v[96:99], v[16:31]
    ds_read_b128 v[96:99], v32 offset:24576
    ds_read_b64_tr_b16 v[100:101], v36 offset:49152
    ds_read_b64_tr_b16 v[102:103], v36 offset:49664
    s_waitcnt lgkmcnt(9)
    v_mfma_f32_32x32x16_bf16 v[16:31], v[108:111], v[104:107], v[16:31]
    ds_read_b128 v[104:107], v33 offset:24576
    ds_read_b64_tr_b16 v[108:109], v36 offset:51200
    ds_read_b64_tr_b16 v[110:111], v36 offset:51712
    s_waitcnt lgkmcnt(9)
    v_mfma_f32_32x32x16_bf16 v[16:31], v[116:119], v[112:115], v[16:31]
    ds_read_b128 v[112:115], v34 offset:24576
    ds_read_b64_tr_b16 v[116:117], v36 offset:53248
    ds_read_b64_tr_b16 v[118:119], v36 offset:53760
    s_waitcnt lgkmcnt(9)
    v_mfma_f32_32x32x16_bf16 v[16:31], v[124:127], v[120:123], v[16:31]
    ds_read_b128 v[120:123], v35 offset:24576
    ds_read_b64_tr_b16 v[124:125], v36 offset:55296
    ds_read_b64_tr_b16 v[126:127], v36 offset:55808
    s_waitcnt lgkmcnt(9)
    v_mfma_f32_32x32x16_bf16 v[16:31], v[100:103], v[96:99], v[16:31]
    s_waitcnt lgkmcnt(0)
    s_barrier
    ds_read_b128 v[96:99], v32 offset:32768
    ds_read_b64_tr_b16 v[100:101], v36 offset:8192
    ds_read_b64_tr_b16 v[102:103], v36 offset:8704
    buffer_load_dwordx4 v[46:49], v2, s[44:47], s82 offen offset:0 sc1
    buffer_load_dwordx4 v[50:53], v2, s[44:47], s82 offen offset:1024 sc1
    v_mfma_f32_32x32x16_bf16 v[16:31], v[108:111], v[104:107], v[16:31]
    ds_read_b128 v[104:107], v33 offset:32768
    ds_read_b64_tr_b16 v[108:109], v36 offset:10240
    ds_read_b64_tr_b16 v[110:111], v36 offset:10752
    s_mov_b64 exec, s[96:97]
    buffer_load_dwordx4 v[54:57], v3, s[44:47], s82 offen offset:2048 sc1
    buffer_load_dwordx4 v[58:61], v3, s[44:47], s82 offen offset:2560 sc1
    buffer_load_dwordx4 v[62:65], v3, s[44:47], s82 offen offset:3072 sc1
    buffer_load_dwordx4 v[66:69], v3, s[44:47], s82 offen offset:3584 sc1
    s_mov_b64 exec, -1
    v_mfma_f32_32x32x16_bf16 v[16:31], v[116:119], v[112:115], v[16:31]
    ds_read_b128 v[112:115], v34 offset:32768
    ds_read_b64_tr_b16 v[116:117], v36 offset:12288
    ds_read_b64_tr_b16 v[118:119], v36 offset:12800
    v_mfma_f32_32x32x16_bf16 v[16:31], v[124:127], v[120:123], v[16:31]
    ds_read_b128 v[120:123], v35 offset:32768
    ds_read_b64_tr_b16 v[124:125], v36 offset:14336
    ds_read_b64_tr_b16 v[126:127], v36 offset:14848
    s_waitcnt lgkmcnt(9)
    v_mfma_f32_32x32x16_bf16 v[16:31], v[100:103], v[96:99], v[16:31]
    ds_read_b128 v[96:99], v32 offset:40960
    ds_read_b64_tr_b16 v[100:101], v36 offset:24576
    ds_read_b64_tr_b16 v[102:103], v36 offset:25088
    s_waitcnt lgkmcnt(9)
    v_mfma_f32_32x32x16_bf16 v[16:31], v[108:111], v[104:107], v[16:31]
    ds_read_b128 v[104:107], v33 offset:40960
    ds_read_b64_tr_b16 v[108:109], v36 offset:26624
    ds_read_b64_tr_b16 v[110:111], v36 offset:27136
    s_waitcnt lgkmcnt(9)
    v_mfma_f32_32x32x16_bf16 v[16:31], v[116:119], v[112:115], v[16:31]
    ds_read_b128 v[112:115], v34 offset:40960
    ds_read_b64_tr_b16 v[116:117], v36 offset:28672
    ds_read_b64_tr_b16 v[118:119], v36 offset:29184
    s_waitcnt lgkmcnt(9)
    v_mfma_f32_32x32x16_bf16 v[16:31], v[124:127], v[120:123], v[16:31]
    ds_read_b128 v[120:123], v35 offset:40960
    ds_read_b64_tr_b16 v[124:125], v36 offset:30720
    ds_read_b64_tr_b16 v[126:127], v36 offset:31232
    s_waitcnt lgkmcnt(9)
    v_mfma_f32_32x32x16_bf16 v[16:31], v[100:103], v[96:99], v[16:31]
    s_waitcnt lgkmcnt(0)
    s_barrier
    ds_read_b128 v[96:99], v32 offset:49152
    ds_read_b64_tr_b16 v[100:101], v36 offset:40960
    ds_read_b64_tr_b16 v[102:103], v36 offset:41472
    v_mfma_f32_32x32x16_bf16 v[16:31], v[108:111], v[104:107], v[16:31]
    ds_read_b128 v[104:107], v33 offset:49152
    ds_read_b64_tr_b16 v[108:109], v36 offset:43008
    ds_read_b64_tr_b16 v[110:111], v36 offset:43520
    v_mfma_f32_32x32x16_bf16 v[16:31], v[116:119], v[112:115], v[16:31]
    ds_read_b128 v[112:115], v34 offset:49152
    ds_read_b64_tr_b16 v[116:117], v36 offset:45056
    ds_read_b64_tr_b16 v[118:119], v36 offset:45568
    v_mfma_f32_32x32x16_bf16 v[16:31], v[124:127], v[120:123], v[16:31]
    ds_read_b128 v[120:123], v35 offset:49152
    ds_read_b64_tr_b16 v[124:125], v36 offset:47104
    ds_read_b64_tr_b16 v[126:127], v36 offset:47616
    s_waitcnt lgkmcnt(9)
    v_mfma_f32_32x32x16_bf16 v[16:31], v[100:103], v[96:99], v[16:31]
    ds_read_b128 v[96:99], v32 offset:57344
    ds_read_b64_tr_b16 v[100:101], v36 offset:57344
    ds_read_b64_tr_b16 v[102:103], v36 offset:57856
    s_waitcnt lgkmcnt(9)
    v_mfma_f32_32x32x16_bf16 v[16:31], v[108:111], v[104:107], v[16:31]
    ds_read_b128 v[104:107], v33 offset:57344
    ds_read_b64_tr_b16 v[108:109], v36 offset:59392
    ds_read_b64_tr_b16 v[110:111], v36 offset:59904
    s_waitcnt lgkmcnt(9)
    v_mfma_f32_32x32x16_bf16 v[16:31], v[116:119], v[112:115], v[16:31]
    ds_read_b128 v[112:115], v34 offset:57344
    ds_read_b64_tr_b16 v[116:117], v36 offset:61440
    ds_read_b64_tr_b16 v[118:119], v36 offset:61952
    s_waitcnt lgkmcnt(9)
    v_mfma_f32_32x32x16_bf16 v[16:31], v[124:127], v[120:123], v[16:31]
    ds_read_b128 v[120:123], v35 offset:57344
    ds_read_b64_tr_b16 v[124:125], v36 offset:63488
    ds_read_b64_tr_b16 v[126:127], v36 offset:64000
    s_waitcnt lgkmcnt(9)
    v_mfma_f32_32x32x16_bf16 v[16:31], v[100:103], v[96:99], v[16:31]
    s_waitcnt lgkmcnt(6)
    v_mfma_f32_32x32x16_bf16 v[16:31], v[108:111], v[104:107], v[16:31]
    s_waitcnt lgkmcnt(3)
    v_mfma_f32_32x32x16_bf16 v[16:31], v[116:119], v[112:115], v[16:31]
    s_waitcnt lgkmcnt(0)
    v_mfma_f32_32x32x16_bf16 v[16:31], v[124:127], v[120:123], v[16:31]
    s_waitcnt vmcnt(0)
    v_xor_b32 v61, s30, v61
    v_bitop3_b32 v61, v61, v54, s30 bitop3:0xf6
    v_bitop3_b32 v61, v61, v62, s30 bitop3:0xf6
    v_bitop3_b32 v61, v61, v68, s30 bitop3:0xf6
    v_cndmask_b32 v61, 0, v61, s[96:97]
    v_bitop3_b32 v61, v61, v46, s30 bitop3:0xf6
    v_bitop3_b32 v61, v61, v52, s30 bitop3:0xf6
    v_cmp_ne_u32 vcc, 0, v61
    s_cbranch_vccnz L_tf0
L_tg0:
    v_mov_b64 v[60:61], v[40:41]
    v_mov_b64 v[62:63], v[42:43]
    v_cvt_pk_bf16_f32 v108, v16, v17
    v_cvt_pk_bf16_f32 v109, v18, v19
    v_cvt_pk_bf16_f32 v110, v20, v21
    v_cvt_pk_bf16_f32 v111, v22, v23
    v_cvt_pk_bf16_f32 v124, v24, v25
    s_setprio 1
    v_mfma_f32_32x32x16_bf16 v[32:47], v[48:51], v[108:111], 0
    ds_write_b128 v63, v[108:111]
    v_cvt_pk_bf16_f32 v125, v26, v27
    v_cvt_pk_bf16_f32 v126, v28, v29
    v_cvt_pk_bf16_f32 v127, v30, v31
    v_mov_b32 v96, 1
    ds_write_b128 v63, v[124:127] offset:1024
    s_mov_b64 exec, s[94:95]
    ds_write_b32 v14, v96 offset:32256
    s_mov_b64 exec, -1
    s_nop 2
    v_exp_f32 v32, v32
    v_exp_f32 v33, v33
    v_exp_f32 v34, v34
    v_exp_f32 v35, v35
    v_exp_f32 v36, v36
    v_mfma_f32_32x32x16_bf16 v[16:31], v[48:51], v[124:127], 0
    v_exp_f32 v37, v37
    v_exp_f32 v38, v38
    v_exp_f32 v39, v39
    v_exp_f32 v40, v40
    ds_read_b32 v63, v14 offset:32256
    ds_read_b128 v[96:99], v60 offset:0
    ds_read_b128 v[100:103], v61 offset:0
    ds_read_b128 v[104:107], v62 offset:0
    ds_read_b128 v[112:115], v60 offset:1024
    ds_read_b128 v[116:119], v61 offset:1024
    ds_read_b128 v[120:123], v62 offset:1024
    v_exp_f32 v41, v41
    v_smfmac_f32_32x32x32_bf16 v[176:191], v[56:59], v[32:39], v1
    v_exp_f32 v42, v42
    v_exp_f32 v43, v43
    v_exp_f32 v44, v44
    buffer_load_dwordx4 v[70:73], v2, s[44:47], s83 offen offset:0 sc1
    buffer_load_dwordx4 v[74:77], v2, s[44:47], s83 offen offset:1024 sc1
    s_mov_b64 exec, s[96:97]
    buffer_load_dwordx4 v[78:81], v3, s[44:47], s83 offen offset:2048 sc1
    buffer_load_dwordx4 v[82:85], v3, s[44:47], s83 offen offset:2560 sc1
    buffer_load_dwordx4 v[86:89], v3, s[44:47], s83 offen offset:3072 sc1
    buffer_load_dwordx4 v[90:93], v3, s[44:47], s83 offen offset:3584 sc1
    s_mov_b64 exec, -1
    v_exp_f32 v45, v45
    v_exp_f32 v46, v46
    v_exp_f32 v47, v47
    v_exp_f32 v16, v16
    v_exp_f32 v17, v17
    v_smfmac_f32_32x32x32_bf16 v[176:191], v[64:67], v[40:47], v1
    v_exp_f32 v18, v18
    v_exp_f32 v19, v19
    v_exp_f32 v20, v20
    s_waitcnt lgkmcnt(0)
    v_cmp_gt_i32 vcc, 1, v63
    s_cbranch_vccnz L_qretry
L_qgot:
    v_mov_b32 v63, 2
    s_mov_b64 exec, s[94:95]
    ds_write_b32 v14, v63 offset:32256
    s_mov_b64 exec, -1
    v_mfma_f32_32x32x16_bf16 v[32:47], v[48:51], v[96:99], 0
    v_exp_f32 v21, v21
    v_exp_f32 v22, v22
    v_exp_f32 v23, v23
    v_exp_f32 v24, v24
    v_exp_f32 v25, v25
    v_smfmac_f32_32x32x32_bf16 v[240:255], v[56:59], v[16:23], v1
    v_exp_f32 v26, v26
    v_exp_f32 v27, v27
    v_exp_f32 v28, v28
    v_exp_f32 v29, v29
    v_exp_f32 v30, v30
    v_exp_f32 v31, v31
    v_exp_f32 v32, v32
    v_exp_f32 v33, v33
    v_smfmac_f32_32x32x32_bf16 v[240:255], v[64:67], v[24:31], v1
    v_exp_f32 v34, v34
    v_exp_f32 v35, v35
    v_exp_f32 v36, v36
    v_mfma_f32_32x32x16_bf16 v[16:31], v[48:51], v[100:103], 0
    v_exp_f32 v37, v37
    v_exp_f32 v38, v38
    v_exp_f32 v39, v39
    v_exp_f32 v40, v40
    v_exp_f32 v41, v41
    v_smfmac_f32_32x32x32_bf16 v[128:143], v[56:59], v[32:39], v1
    v_exp_f32 v42, v42
    v_exp_f32 v43, v43
    v_exp_f32 v44, v44
    v_exp_f32 v45, v45
    v_exp_f32 v46, v46
    v_exp_f32 v47, v47
    v_exp_f32 v16, v16
    v_exp_f32 v17, v17
    v_smfmac_f32_32x32x32_bf16 v[128:143], v[64:67], v[40:47], v1
    v_exp_f32 v18, v18
    v_exp_f32 v19, v19
    v_exp_f32 v20, v20
    v_mfma_f32_32x32x16_bf16 v[32:47], v[48:51], v[104:107], 0
    v_exp_f32 v21, v21
    v_exp_f32 v22, v22
    v_exp_f32 v23, v23
    v_exp_f32 v24, v24
    v_exp_f32 v25, v25
    v_smfmac_f32_32x32x32_bf16 v[144:159], v[56:59], v[16:23], v1
    v_exp_f32 v26, v26
    v_exp_f32 v27, v27
    v_exp_f32 v28, v28
    v_exp_f32 v29, v29
    v_exp_f32 v30, v30
    v_exp_f32 v31, v31
    v_exp_f32 v32, v32
    v_exp_f32 v33, v33
    v_smfmac_f32_32x32x32_bf16 v[144:159], v[64:67], v[24:31], v1
    v_exp_f32 v34, v34
    v_exp_f32 v35, v35
    v_exp_f32 v36, v36
    v_mfma_f32_32x32x16_bf16 v[16:31], v[48:51], v[112:115], 0
    v_exp_f32 v37, v37
    v_exp_f32 v38, v38
    v_exp_f32 v39, v39
    v_exp_f32 v40, v40
    v_exp_f32 v41, v41
    v_smfmac_f32_32x32x32_bf16 v[160:175], v[56:59], v[32:39], v1
    v_exp_f32 v42, v42
    v_exp_f32 v43, v43
    v_exp_f32 v44, v44
    v_exp_f32 v45, v45
    v_exp_f32 v46, v46
    v_exp_f32 v47, v47
    v_exp_f32 v16, v16
    v_exp_f32 v17, v17
    v_smfmac_f32_32x32x32_bf16 v[160:175], v[64:67], v[40:47], v1
    v_exp_f32 v18, v18
    v_exp_f32 v19, v19
    v_exp_f32 v20, v20
    v_mfma_f32_32x32x16_bf16 v[32:47], v[48:51], v[116:119], 0
    v_exp_f32 v21, v21
    v_exp_f32 v22, v22
    v_exp_f32 v23, v23
    v_exp_f32 v24, v24
    v_exp_f32 v25, v25
    v_smfmac_f32_32x32x32_bf16 v[192:207], v[56:59], v[16:23], v1
    v_exp_f32 v26, v26
    v_exp_f32 v27, v27
    buffer_load_dword v60, v13, s[44:47], s90 offen sc1
    buffer_load_dwordx2 v[62:63], v13, s[44:47], s91 offen sc1
    v_exp_f32 v28, v28
    v_exp_f32 v29, v29
    v_exp_f32 v30, v30
    v_exp_f32 v31, v31
    v_exp_f32 v32, v32
    v_exp_f32 v33, v33
    v_smfmac_f32_32x32x32_bf16 v[192:207], v[64:67], v[24:31], v1
    v_exp_f32 v34, v34
    v_exp_f32 v35, v35
    v_exp_f32 v36, v36
    v_mfma_f32_32x32x16_bf16 v[16:31], v[48:51], v[120:123], 0
    v_exp_f32 v37, v37
    s_waitcnt vmcnt(2)
    v_xor_b32 v85, s30, v85
    v_bitop3_b32 v85, v85, v78, s30 bitop3:0xf6
    v_bitop3_b32 v85, v85, v86, s30 bitop3:0xf6
    v_bitop3_b32 v85, v85, v92, s30 bitop3:0xf6
    v_cndmask_b32 v85, 0, v85, s[96:97]
    v_bitop3_b32 v85, v85, v70, s30 bitop3:0xf6
    v_bitop3_b32 v85, v85, v76, s30 bitop3:0xf6
    v_cmp_ne_u32 vcc, 0, v85
    s_cbranch_vccnz L_tf1
L_tg1:
    v_exp_f32 v38, v38
    v_exp_f32 v39, v39
    v_exp_f32 v40, v40
    v_exp_f32 v41, v41
    v_smfmac_f32_32x32x32_bf16 v[208:223], v[56:59], v[32:39], v1
    v_exp_f32 v42, v42
    v_exp_f32 v43, v43
    v_exp_f32 v44, v44
    v_exp_f32 v45, v45
    v_exp_f32 v46, v46
    v_exp_f32 v47, v47
    v_exp_f32 v16, v16
    v_exp_f32 v17, v17
    v_exp_f32 v18, v18
    v_smfmac_f32_32x32x32_bf16 v[208:223], v[64:67], v[40:47], v1
    v_exp_f32 v19, v19
    v_exp_f32 v20, v20
    v_mfma_f32_32x32x16_bf16 v[32:47], v[72:75], v[96:99], 0
    v_exp_f32 v21, v21
    v_exp_f32 v22, v22
    v_exp_f32 v23, v23
    v_exp_f32 v24, v24
    v_exp_f32 v25, v25
    v_exp_f32 v26, v26
    v_exp_f32 v27, v27
    v_exp_f32 v28, v28
    v_exp_f32 v29, v29
    v_exp_f32 v30, v30
    v_exp_f32 v31, v31
    v_smfmac_f32_32x32x32_bf16 v[224:239], v[56:59], v[16:23], v1
    v_exp_f32 v32, v32
    v_exp_f32 v33, v33
    v_exp_f32 v34, v34
    v_smfmac_f32_32x32x32_bf16 v[224:239], v[64:67], v[24:31], v1
    v_exp_f32 v35, v35
    v_exp_f32 v36, v36
    v_mfma_f32_32x32x16_bf16 v[16:31], v[72:75], v[100:103], 0
    v_exp_f32 v37, v37
    v_exp_f32 v38, v38
    v_exp_f32 v39, v39
    v_exp_f32 v40, v40
    v_exp_f32 v41, v41
    v_exp_f32 v42, v42
    v_exp_f32 v43, v43
    v_exp_f32 v44, v44
    v_exp_f32 v45, v45
    v_exp_f32 v46, v46
    v_exp_f32 v47, v47
    v_smfmac_f32_32x32x32_bf16 v[128:143], v[80:83], v[32:39], v1
    v_exp_f32 v16, v16
    v_exp_f32 v17, v17
    v_exp_f32 v18, v18
    v_smfmac_f32_32x32x32_bf16 v[128:143], v[88:91], v[40:47], v1
    v_exp_f32 v19, v19
    v_exp_f32 v20, v20
    v_mfma_f32_32x32x16_bf16 v[32:47], v[72:75], v[104:107], 0
    v_exp_f32 v21, v21
    v_exp_f32 v22, v22
    s_waitcnt vmcnt(0)
    v_cmp_ne_u32 vcc, s30, v60
    s_cbranch_vccnz L_fretry
L_fgot:
    buffer_load_dwordx4 v[48:51], v2, s[44:47], s61 offen offset:0 sc1
    buffer_load_dwordx4 v[52:55], v3, s[44:47], s61 offen offset:1024 sc1
    buffer_load_dwordx4 v[56:59], v3, s[44:47], s61 offen offset:1536 sc1
    v_exp_f32 v23, v23
    v_exp_f32 v24, v24
    v_exp_f32 v25, v25
    v_exp_f32 v26, v26
    v_exp_f32 v27, v27
    v_exp_f32 v28, v28
    v_exp_f32 v29, v29
    v_exp_f32 v30, v30
    v_exp_f32 v31, v31
    v_smfmac_f32_32x32x32_bf16 v[144:159], v[80:83], v[16:23], v1
    v_exp_f32 v32, v32
    v_exp_f32 v33, v33
    v_exp_f32 v34, v34
    v_smfmac_f32_32x32x32_bf16 v[144:159], v[88:91], v[24:31], v1
    v_exp_f32 v35, v35
    v_exp_f32 v36, v36
    v_mfma_f32_32x32x16_bf16 v[16:31], v[72:75], v[108:111], 0
    v_exp_f32 v37, v37
    v_exp_f32 v38, v38
    v_cmp_ne_u64 vcc, s[36:37], v[62:63]
    s_and_b32 s38, vcc_lo, 0xff
    s_cselect_b32 s91, 3, 0x10003
    v_mov_b32 v13, s91
    s_mov_b64 exec, s[94:95]
    ds_write_b32 v14, v13 offset:32256
    s_mov_b64 exec, -1
    v_exp_f32 v39, v39
    v_exp_f32 v40, v40
    v_exp_f32 v41, v41
    v_exp_f32 v42, v42
    v_exp_f32 v43, v43
    v_exp_f32 v44, v44
    v_exp_f32 v45, v45
    v_exp_f32 v46, v46
    v_exp_f32 v47, v47
    v_smfmac_f32_32x32x32_bf16 v[160:175], v[80:83], v[32:39], v1
    v_exp_f32 v16, v16
    v_exp_f32 v17, v17
    v_exp_f32 v18, v18
    v_smfmac_f32_32x32x32_bf16 v[160:175], v[88:91], v[40:47], v1
    v_exp_f32 v19, v19
    v_exp_f32 v20, v20
    v_mfma_f32_32x32x16_bf16 v[32:47], v[72:75], v[112:115], 0
    v_exp_f32 v21, v21
    buffer_load_dwordx4 v[60:63], v2, s[44:47], s61 offen offset:2048 sc1
    buffer_load_dwordx4 v[64:67], v3, s[44:47], s61 offen offset:3072 sc1
    buffer_load_dwordx4 v[68:71], v3, s[44:47], s61 offen offset:3584 sc1
    v_exp_f32 v22, v22
    v_exp_f32 v23, v23
    v_exp_f32 v24, v24
    v_exp_f32 v25, v25
    v_exp_f32 v26, v26
    v_exp_f32 v27, v27
    v_exp_f32 v28, v28
    v_exp_f32 v29, v29
    v_exp_f32 v30, v30
    v_exp_f32 v31, v31
    v_smfmac_f32_32x32x32_bf16 v[176:191], v[80:83], v[16:23], v1
    v_exp_f32 v32, v32
    v_exp_f32 v33, v33
    v_exp_f32 v34, v34
    v_smfmac_f32_32x32x32_bf16 v[176:191], v[88:91], v[24:31], v1
    v_exp_f32 v35, v35
    v_exp_f32 v36, v36
    v_mfma_f32_32x32x16_bf16 v[16:31], v[72:75], v[116:119], 0
    v_exp_f32 v37, v37
    v_exp_f32 v38, v38
    v_exp_f32 v39, v39
    v_exp_f32 v40, v40
    v_exp_f32 v41, v41
    v_exp_f32 v42, v42
    v_exp_f32 v43, v43
    v_exp_f32 v44, v44
    v_exp_f32 v45, v45
    v_exp_f32 v46, v46
    v_exp_f32 v47, v47
    v_smfmac_f32_32x32x32_bf16 v[192:207], v[80:83], v[32:39], v1
    v_exp_f32 v16, v16
    v_exp_f32 v17, v17
    v_exp_f32 v18, v18
    v_smfmac_f32_32x32x32_bf16 v[192:207], v[88:91], v[40:47], v1
    v_exp_f32 v19, v19
    v_exp_f32 v20, v20
    v_mfma_f32_32x32x16_bf16 v[32:47], v[72:75], v[120:123], 0
    v_exp_f32 v21, v21
    v_exp_f32 v22, v22
    v_exp_f32 v23, v23
    v_exp_f32 v24, v24
    v_exp_f32 v25, v25
    v_exp_f32 v26, v26
    v_exp_f32 v27, v27
    v_exp_f32 v28, v28
    v_exp_f32 v29, v29
    v_exp_f32 v30, v30
    v_exp_f32 v31, v31
    v_smfmac_f32_32x32x32_bf16 v[208:223], v[80:83], v[16:23], v1
    v_exp_f32 v32, v32
    v_exp_f32 v33, v33
    v_exp_f32 v34, v34
    v_smfmac_f32_32x32x32_bf16 v[208:223], v[88:91], v[24:31], v1
    v_exp_f32 v35, v35
    v_exp_f32 v36, v36
    v_mfma_f32_32x32x16_bf16 v[16:31], v[72:75], v[124:127], 0
    v_exp_f32 v37, v37
    v_exp_f32 v38, v38
    v_exp_f32 v39, v39
    v_exp_f32 v40, v40
    v_exp_f32 v41, v41
    v_exp_f32 v42, v42
    v_exp_f32 v43, v43
    v_exp_f32 v44, v44
    v_exp_f32 v45, v45
    s_waitcnt vmcnt(3)
    v_exp_f32 v46, v46
    v_exp_f32 v47, v47
    v_smfmac_f32_32x32x32_bf16 v[224:239], v[80:83], v[32:39], v1
    v_exp_f32 v16, v16
    v_exp_f32 v17, v17
    v_exp_f32 v18, v18
    v_smfmac_f32_32x32x32_bf16 v[224:239], v[88:91], v[40:47], v1
    v_exp_f32 v19, v19
    v_exp_f32 v20, v20
    v_mfma_f32_32x32x16_bf16 v[32:47], v[48:51], v[96:99], 0
    v_exp_f32 v21, v21
    v_exp_f32 v22, v22
    v_exp_f32 v23, v23
    v_exp_f32 v24, v24
    v_exp_f32 v25, v25
    v_exp_f32 v26, v26
    v_exp_f32 v27, v27
    v_exp_f32 v28, v28
    v_exp_f32 v29, v29
    v_exp_f32 v30, v30
    v_exp_f32 v31, v31
    v_smfmac_f32_32x32x32_bf16 v[240:255], v[80:83], v[16:23], v1
    v_exp_f32 v32, v32
    v_exp_f32 v33, v33
    v_exp_f32 v34, v34
    v_smfmac_f32_32x32x32_bf16 v[240:255], v[88:91], v[24:31], v1
    v_exp_f32 v35, v35
    v_exp_f32 v36, v36
    v_mfma_f32_32x32x16_bf16 v[16:31], v[48:51], v[100:103], 0
    v_exp_f32 v37, v37
    buffer_load_dwordx4 v[72:75], v2, s[44:47], s62 offen offset:0 sc1
    buffer_load_dwordx4 v[76:79], v3, s[44:47], s62 offen offset:1024 sc1
    buffer_load_dwordx4 v[80:83], v3, s[44:47], s62 offen offset:1536 sc1
    v_exp_f32 v38, v38
    v_exp_f32 v39, v39
    v_exp_f32 v40, v40
    v_exp_f32 v41, v41
    v_exp_f32 v42, v42
    v_exp_f32 v43, v43
    v_exp_f32 v44, v44
    v_exp_f32 v45, v45
    v_exp_f32 v46, v46
    v_exp_f32 v47, v47
    v_smfmac_f32_32x32x32_bf16 v[128:143], v[52:55], v[32:39], v1
    v_exp_f32 v16, v16
    v_exp_f32 v17, v17
    v_exp_f32 v18, v18
    v_smfmac_f32_32x32x32_bf16 v[128:143], v[56:59], v[40:47], v1
    v_exp_f32 v19, v19
    v_exp_f32 v20, v20
    v_mfma_f32_32x32x16_bf16 v[32:47], v[48:51], v[104:107], 0
    v_exp_f32 v21, v21
    v_exp_f32 v22, v22
    v_exp_f32 v23, v23
    v_exp_f32 v24, v24
    v_exp_f32 v25, v25
    v_exp_f32 v26, v26
    v_exp_f32 v27, v27
    v_exp_f32 v28, v28
    v_exp_f32 v29, v29
    v_exp_f32 v30, v30
    v_exp_f32 v31, v31
    v_smfmac_f32_32x32x32_bf16 v[144:159], v[52:55], v[16:23], v1
    v_exp_f32 v32, v32
    v_exp_f32 v33, v33
    v_exp_f32 v34, v34
    v_smfmac_f32_32x32x32_bf16 v[144:159], v[56:59], v[24:31], v1
    v_exp_f32 v35, v35
    v_exp_f32 v36, v36
    v_mfma_f32_32x32x16_bf16 v[16:31], v[48:51], v[108:111], 0
    v_exp_f32 v37, v37
    buffer_load_dwordx4 v[84:87], v2, s[44:47], s62 offen offset:2048 sc1
    buffer_load_dwordx4 v[88:91], v3, s[44:47], s62 offen offset:3072 sc1
    buffer_load_dwordx4 v[92:95], v3, s[44:47], s62 offen offset:3584 sc1
    s_waitcnt vmcnt(6)
    v_exp_f32 v38, v38
    v_exp_f32 v39, v39
    v_exp_f32 v40, v40
    v_exp_f32 v41, v41
    v_exp_f32 v42, v42
    v_exp_f32 v43, v43
    v_exp_f32 v44, v44
    v_exp_f32 v45, v45
    v_exp_f32 v46, v46
    v_exp_f32 v47, v47
    v_smfmac_f32_32x32x32_bf16 v[160:175], v[52:55], v[32:39], v1
    v_exp_f32 v16, v16
    v_exp_f32 v17, v17
    v_exp_f32 v18, v18
    v_smfmac_f32_32x32x32_bf16 v[160:175], v[56:59], v[40:47], v1
    v_exp_f32 v19, v19
    v_exp_f32 v20, v20
    v_mfma_f32_32x32x16_bf16 v[32:47], v[48:51], v[112:115], 0
    v_exp_f32 v21, v21
    v_exp_f32 v22, v22
    v_exp_f32 v23, v23
    v_exp_f32 v24, v24
    v_exp_f32 v25, v25
    v_exp_f32 v26, v26
    v_exp_f32 v27, v27
    v_exp_f32 v28, v28
    v_exp_f32 v29, v29
    v_exp_f32 v30, v30
    v_exp_f32 v31, v31
    v_smfmac_f32_32x32x32_bf16 v[176:191], v[52:55], v[16:23], v1
    v_exp_f32 v32, v32
    v_exp_f32 v33, v33
    v_exp_f32 v34, v34
    v_smfmac_f32_32x32x32_bf16 v[176:191], v[56:59], v[24:31], v1
    v_exp_f32 v35, v35
    v_exp_f32 v36, v36
    v_mfma_f32_32x32x16_bf16 v[16:31], v[48:51], v[116:119], 0
    v_exp_f32 v37, v37
    v_exp_f32 v38, v38
    v_exp_f32 v39, v39
    v_exp_f32 v40, v40
    v_exp_f32 v41, v41
    v_exp_f32 v42, v42
    v_exp_f32 v43, v43
    v_exp_f32 v44, v44
    v_exp_f32 v45, v45
    v_exp_f32 v46, v46
    v_exp_f32 v47, v47
    v_smfmac_f32_32x32x32_bf16 v[192:207], v[52:55], v[32:39], v1
    v_exp_f32 v16, v16
    v_exp_f32 v17, v17
    v_exp_f32 v18, v18
    v_smfmac_f32_32x32x32_bf16 v[192:207], v[56:59], v[40:47], v1
    v_exp_f32 v19, v19
    v_exp_f32 v20, v20
    v_mfma_f32_32x32x16_bf16 v[32:47], v[48:51], v[120:123], 0
    v_exp_f32 v21, v21
    v_exp_f32 v22, v22
    v_exp_f32 v23, v23
    v_exp_f32 v24, v24
    v_exp_f32 v25, v25
    v_exp_f32 v26, v26
    v_exp_f32 v27, v27
    v_exp_f32 v28, v28
    v_exp_f32 v29, v29
    v_exp_f32 v30, v30
    v_exp_f32 v31, v31
    v_smfmac_f32_32x32x32_bf16 v[208:223], v[52:55], v[16:23], v1
    v_exp_f32 v32, v32
    v_exp_f32 v33, v33
    v_exp_f32 v34, v34
    v_smfmac_f32_32x32x32_bf16 v[208:223], v[56:59], v[24:31], v1
    v_exp_f32 v35, v35
    v_exp_f32 v36, v36
    v_mfma_f32_32x32x16_bf16 v[16:31], v[48:51], v[124:127], 0
    v_exp_f32 v37, v37
    v_exp_f32 v38, v38
    v_exp_f32 v39, v39
    v_exp_f32 v40, v40
    v_exp_f32 v41, v41
    v_exp_f32 v42, v42
    v_exp_f32 v43, v43
    v_exp_f32 v44, v44
    v_exp_f32 v45, v45
    v_exp_f32 v46, v46
    v_exp_f32 v47, v47
    v_smfmac_f32_32x32x32_bf16 v[224:239], v[52:55], v[32:39], v1
    v_exp_f32 v16, v16
    v_exp_f32 v17, v17
    v_exp_f32 v18, v18
    v_smfmac_f32_32x32x32_bf16 v[224:239], v[56:59], v[40:47], v1
    v_exp_f32 v19, v19
    v_exp_f32 v20, v20
    v_mfma_f32_32x32x16_bf16 v[32:47], v[60:63], v[96:99], 0
    v_exp_f32 v21, v21
    v_exp_f32 v22, v22
    v_exp_f32 v23, v23
    v_exp_f32 v24, v24
    v_exp_f32 v25, v25
    v_exp_f32 v26, v26
    v_exp_f32 v27, v27
    v_exp_f32 v28, v28
    v_exp_f32 v29, v29
    v_exp_f32 v30, v30
    v_exp_f32 v31, v31
    v_smfmac_f32_32x32x32_bf16 v[240:255], v[52:55], v[16:23], v1
    v_exp_f32 v32, v32
    v_exp_f32 v33, v33
    v_exp_f32 v34, v34
    v_smfmac_f32_32x32x32_bf16 v[240:255], v[56:59], v[24:31], v1
    v_exp_f32 v35, v35
    v_exp_f32 v36, v36
    v_mfma_f32_32x32x16_bf16 v[16:31], v[60:63], v[100:103], 0
    v_exp_f32 v37, v37
    buffer_load_dwordx4 v[48:51], v2, s[44:47], s63 offen offset:0 sc1
    buffer_load_dwordx4 v[52:55], v3, s[44:47], s63 offen offset:1024 sc1
    buffer_load_dwordx4 v[56:59], v3, s[44:47], s63 offen offset:1536 sc1
    s_waitcnt vmcnt(6)
    v_exp_f32 v38, v38
    v_exp_f32 v39, v39
    v_exp_f32 v40, v40
    v_exp_f32 v41, v41
    v_exp_f32 v42, v42
    v_exp_f32 v43, v43
    v_exp_f32 v44, v44
    v_exp_f32 v45, v45
    v_exp_f32 v46, v46
    v_exp_f32 v47, v47
    v_smfmac_f32_32x32x32_bf16 v[128:143], v[64:67], v[32:39], v1
    v_exp_f32 v16, v16
    v_exp_f32 v17, v17
    v_exp_f32 v18, v18
    v_smfmac_f32_32x32x32_bf16 v[128:143], v[68:71], v[40:47], v1
    v_exp_f32 v19, v19
    v_exp_f32 v20, v20
    v_mfma_f32_32x32x16_bf16 v[32:47], v[60:63], v[104:107], 0
    v_exp_f32 v21, v21
    v_exp_f32 v22, v22
    v_exp_f32 v23, v23
    v_exp_f32 v24, v24
    v_exp_f32 v25, v25
    v_exp_f32 v26, v26
    v_exp_f32 v27, v27
    v_exp_f32 v28, v28
    v_exp_f32 v29, v29
    v_exp_f32 v30, v30
    v_exp_f32 v31, v31
    v_smfmac_f32_32x32x32_bf16 v[144:159], v[64:67], v[16:23], v1
    v_exp_f32 v32, v32
    v_exp_f32 v33, v33
    v_exp_f32 v34, v34
    v_smfmac_f32_32x32x32_bf16 v[144:159], v[68:71], v[24:31], v1
    v_exp_f32 v35, v35
    v_exp_f32 v36, v36
    v_mfma_f32_32x32x16_bf16 v[16:31], v[60:63], v[108:111], 0
    v_exp_f32 v37, v37
    v_exp_f32 v38, v38
    v_exp_f32 v39, v39
    v_exp_f32 v40, v40
    v_exp_f32 v41, v41
    v_exp_f32 v42, v42
    v_exp_f32 v43, v43
    v_exp_f32 v44, v44
    v_exp_f32 v45, v45
    v_exp_f32 v46, v46
    v_exp_f32 v47, v47
    v_smfmac_f32_32x32x32_bf16 v[160:175], v[64:67], v[32:39], v1
    v_exp_f32 v16, v16
    v_exp_f32 v17, v17
    v_exp_f32 v18, v18
    v_smfmac_f32_32x32x32_bf16 v[160:175], v[68:71], v[40:47], v1
    v_exp_f32 v19, v19
    v_exp_f32 v20, v20
    v_mfma_f32_32x32x16_bf16 v[32:47], v[60:63], v[112:115], 0
    v_exp_f32 v21, v21
    v_exp_f32 v22, v22
    v_exp_f32 v23, v23
    v_exp_f32 v24, v24
    v_exp_f32 v25, v25
    v_exp_f32 v26, v26
    v_exp_f32 v27, v27
    v_exp_f32 v28, v28
    v_exp_f32 v29, v29
    v_exp_f32 v30, v30
    v_exp_f32 v31, v31
    v_smfmac_f32_32x32x32_bf16 v[176:191], v[64:67], v[16:23], v1
    v_exp_f32 v32, v32
    v_exp_f32 v33, v33
    v_exp_f32 v34, v34
    v_smfmac_f32_32x32x32_bf16 v[176:191], v[68:71], v[24:31], v1
    v_exp_f32 v35, v35
    v_exp_f32 v36, v36
    v_mfma_f32_32x32x16_bf16 v[16:31], v[60:63], v[116:119], 0
    v_exp_f32 v37, v37
    v_exp_f32 v38, v38
    v_exp_f32 v39, v39
    v_exp_f32 v40, v40
    v_exp_f32 v41, v41
    v_exp_f32 v42, v42
    v_exp_f32 v43, v43
    v_exp_f32 v44, v44
    v_exp_f32 v45, v45
    v_exp_f32 v46, v46
    v_exp_f32 v47, v47
    v_smfmac_f32_32x32x32_bf16 v[192:207], v[64:67], v[32:39], v1
    v_exp_f32 v16, v16
    v_exp_f32 v17, v17
    v_exp_f32 v18, v18
    v_smfmac_f32_32x32x32_bf16 v[192:207], v[68:71], v[40:47], v1
    v_exp_f32 v19, v19
    v_exp_f32 v20, v20
    v_mfma_f32_32x32x16_bf16 v[32:47], v[60:63], v[120:123], 0
    v_exp_f32 v21, v21
    v_exp_f32 v22, v22
    v_exp_f32 v23, v23
    v_exp_f32 v24, v24
    v_exp_f32 v25, v25
    v_exp_f32 v26, v26
    v_exp_f32 v27, v27
    v_exp_f32 v28, v28
    v_exp_f32 v29, v29
    v_exp_f32 v30, v30
    v_exp_f32 v31, v31
    v_smfmac_f32_32x32x32_bf16 v[208:223], v[64:67], v[16:23], v1
    v_exp_f32 v32, v32
    v_exp_f32 v33, v33
    v_exp_f32 v34, v34
    v_smfmac_f32_32x32x32_bf16 v[208:223], v[68:71], v[24:31], v1
    v_exp_f32 v35, v35
    v_exp_f32 v36, v36
    v_mfma_f32_32x32x16_bf16 v[16:31], v[60:63], v[124:127], 0
    v_exp_f32 v37, v37
    v_exp_f32 v38, v38
    v_exp_f32 v39, v39
    v_exp_f32 v40, v40
    v_exp_f32 v41, v41
    v_exp_f32 v42, v42
    v_exp_f32 v43, v43
    v_exp_f32 v44, v44
    v_exp_f32 v45, v45
    v_exp_f32 v46, v46
    v_exp_f32 v47, v47
    v_smfmac_f32_32x32x32_bf16 v[224:239], v[64:67], v[32:39], v1
    v_exp_f32 v16, v16
    v_exp_f32 v17, v17
    v_exp_f32 v18, v18
    v_smfmac_f32_32x32x32_bf16 v[224:239], v[68:71], v[40:47], v1
    v_exp_f32 v19, v19
    v_exp_f32 v20, v20
    v_mfma_f32_32x32x16_bf16 v[32:47], v[72:75], v[96:99], 0
    v_exp_f32 v21, v21
    v_exp_f32 v22, v22
    v_exp_f32 v23, v23
    v_exp_f32 v24, v24
    v_exp_f32 v25, v25
    v_exp_f32 v26, v26
    v_exp_f32 v27, v27
    v_exp_f32 v28, v28
    v_exp_f32 v29, v29
    v_exp_f32 v30, v30
    v_exp_f32 v31, v31
    v_smfmac_f32_32x32x32_bf16 v[240:255], v[64:67], v[16:23], v1
    v_exp_f32 v32, v32
    v_exp_f32 v33, v33
    v_exp_f32 v34, v34
    v_smfmac_f32_32x32x32_bf16 v[240:255], v[68:71], v[24:31], v1
    v_exp_f32 v35, v35
    v_exp_f32 v36, v36
    v_mfma_f32_32x32x16_bf16 v[16:31], v[72:75], v[100:103], 0
    v_exp_f32 v37, v37
    buffer_load_dwordx4 v[60:63], v2, s[44:47], s63 offen offset:2048 sc1
    buffer_load_dwordx4 v[64:67], v3, s[44:47], s63 offen offset:3072 sc1
    buffer_load_dwordx4 v[68:71], v3, s[44:47], s63 offen offset:3584 sc1
    s_waitcnt vmcnt(6)
    v_exp_f32 v38, v38
    v_exp_f32 v39, v39
    v_exp_f32 v40, v40
    v_exp_f32 v41, v41
    v_exp_f32 v42, v42
    v_exp_f32 v43, v43
    v_exp_f32 v44, v44
    v_exp_f32 v45, v45
    v_exp_f32 v46, v46
    v_exp_f32 v47, v47
    v_smfmac_f32_32x32x32_bf16 v[128:143], v[76:79], v[32:39], v1
    v_exp_f32 v16, v16
    v_exp_f32 v17, v17
    v_exp_f32 v18, v18
    v_smfmac_f32_32x32x32_bf16 v[128:143], v[80:83], v[40:47], v1
    v_exp_f32 v19, v19
    v_exp_f32 v20, v20
    v_mfma_f32_32x32x16_bf16 v[32:47], v[72:75], v[104:107], 0
    v_exp_f32 v21, v21
    v_exp_f32 v22, v22
    v_exp_f32 v23, v23
    v_exp_f32 v24, v24
    v_exp_f32 v25, v25
    v_exp_f32 v26, v26
    v_exp_f32 v27, v27
    v_exp_f32 v28, v28
    v_exp_f32 v29, v29
    v_exp_f32 v30, v30
    v_exp_f32 v31, v31
    v_smfmac_f32_32x32x32_bf16 v[144:159], v[76:79], v[16:23], v1
    v_exp_f32 v32, v32
    v_exp_f32 v33, v33
    v_exp_f32 v34, v34
    v_smfmac_f32_32x32x32_bf16 v[144:159], v[80:83], v[24:31], v1
    v_exp_f32 v35, v35
    v_exp_f32 v36, v36
    v_mfma_f32_32x32x16_bf16 v[16:31], v[72:75], v[108:111], 0
    v_exp_f32 v37, v37
    v_exp_f32 v38, v38
    v_exp_f32 v39, v39
    v_exp_f32 v40, v40
    v_exp_f32 v41, v41
    v_exp_f32 v42, v42
    v_exp_f32 v43, v43
    v_exp_f32 v44, v44
    v_exp_f32 v45, v45
    v_exp_f32 v46, v46
    v_exp_f32 v47, v47
    v_smfmac_f32_32x32x32_bf16 v[160:175], v[76:79], v[32:39], v1
    v_exp_f32 v16, v16
    v_exp_f32 v17, v17
    v_exp_f32 v18, v18
    v_smfmac_f32_32x32x32_bf16 v[160:175], v[80:83], v[40:47], v1
    v_exp_f32 v19, v19
    v_exp_f32 v20, v20
    v_mfma_f32_32x32x16_bf16 v[32:47], v[72:75], v[112:115], 0
    v_exp_f32 v21, v21
    v_exp_f32 v22, v22
    v_exp_f32 v23, v23
    v_exp_f32 v24, v24
    v_exp_f32 v25, v25
    v_exp_f32 v26, v26
    v_exp_f32 v27, v27
    v_exp_f32 v28, v28
    v_exp_f32 v29, v29
    v_exp_f32 v30, v30
    v_exp_f32 v31, v31
    v_smfmac_f32_32x32x32_bf16 v[176:191], v[76:79], v[16:23], v1
    v_exp_f32 v32, v32
    v_exp_f32 v33, v33
    v_exp_f32 v34, v34
    v_smfmac_f32_32x32x32_bf16 v[176:191], v[80:83], v[24:31], v1
    v_exp_f32 v35, v35
    v_exp_f32 v36, v36
    v_mfma_f32_32x32x16_bf16 v[16:31], v[72:75], v[116:119], 0
    v_exp_f32 v37, v37
    v_exp_f32 v38, v38
    v_exp_f32 v39, v39
    v_exp_f32 v40, v40
    v_exp_f32 v41, v41
    v_exp_f32 v42, v42
    v_exp_f32 v43, v43
    v_exp_f32 v44, v44
    v_exp_f32 v45, v45
    v_exp_f32 v46, v46
    v_exp_f32 v47, v47
    v_smfmac_f32_32x32x32_bf16 v[192:207], v[76:79], v[32:39], v1
    v_exp_f32 v16, v16
    v_exp_f32 v17, v17
    v_exp_f32 v18, v18
    v_smfmac_f32_32x32x32_bf16 v[192:207], v[80:83], v[40:47], v1
    v_exp_f32 v19, v19
    v_exp_f32 v20, v20
    v_mfma_f32_32x32x16_bf16 v[32:47], v[72:75], v[120:123], 0
    v_exp_f32 v21, v21
    v_exp_f32 v22, v22
    v_exp_f32 v23, v23
    v_exp_f32 v24, v24
    v_exp_f32 v25, v25
    v_exp_f32 v26, v26
    v_exp_f32 v27, v27
    v_exp_f32 v28, v28
    v_exp_f32 v29, v29
    v_exp_f32 v30, v30
    v_exp_f32 v31, v31
    v_smfmac_f32_32x32x32_bf16 v[208:223], v[76:79], v[16:23], v1
    v_exp_f32 v32, v32
    v_exp_f32 v33, v33
    v_exp_f32 v34, v34
    v_smfmac_f32_32x32x32_bf16 v[208:223], v[80:83], v[24:31], v1
    v_exp_f32 v35, v35
    v_exp_f32 v36, v36
    v_mfma_f32_32x32x16_bf16 v[16:31], v[72:75], v[124:127], 0
    v_exp_f32 v37, v37
    v_exp_f32 v38, v38
    v_exp_f32 v39, v39
    v_exp_f32 v40, v40
    v_exp_f32 v41, v41
    v_exp_f32 v42, v42
    v_exp_f32 v43, v43
    v_exp_f32 v44, v44
    v_exp_f32 v45, v45
    v_exp_f32 v46, v46
    v_exp_f32 v47, v47
    v_smfmac_f32_32x32x32_bf16 v[224:239], v[76:79], v[32:39], v1
    v_exp_f32 v16, v16
    v_exp_f32 v17, v17
    v_exp_f32 v18, v18
    v_smfmac_f32_32x32x32_bf16 v[224:239], v[80:83], v[40:47], v1
    v_exp_f32 v19, v19
    v_exp_f32 v20, v20
    v_mfma_f32_32x32x16_bf16 v[32:47], v[84:87], v[96:99], 0
    v_exp_f32 v21, v21
    v_exp_f32 v22, v22
    v_exp_f32 v23, v23
    v_exp_f32 v24, v24
    v_exp_f32 v25, v25
    v_exp_f32 v26, v26
    v_exp_f32 v27, v27
    v_exp_f32 v28, v28
    v_exp_f32 v29, v29
    v_exp_f32 v30, v30
    v_exp_f32 v31, v31
    v_smfmac_f32_32x32x32_bf16 v[240:255], v[76:79], v[16:23], v1
    v_exp_f32 v32, v32
    v_exp_f32 v33, v33
    v_exp_f32 v34, v34
    v_smfmac_f32_32x32x32_bf16 v[240:255], v[80:83], v[24:31], v1
    v_exp_f32 v35, v35
    v_exp_f32 v36, v36
    v_mfma_f32_32x32x16_bf16 v[16:31], v[84:87], v[100:103], 0
    v_exp_f32 v37, v37
    buffer_load_dwordx4 v[72:75], v2, s[44:47], s64 offen offset:0 sc1
    buffer_load_dwordx4 v[76:79], v3, s[44:47], s64 offen offset:1024 sc1
    buffer_load_dwordx4 v[80:83], v3, s[44:47], s64 offen offset:1536 sc1
    s_waitcnt vmcnt(6)
    v_exp_f32 v38, v38
    v_exp_f32 v39, v39
    v_exp_f32 v40, v40
    v_exp_f32 v41, v41
    v_exp_f32 v42, v42
    v_exp_f32 v43, v43
    v_exp_f32 v44, v44
    v_exp_f32 v45, v45
    v_exp_f32 v46, v46
    v_exp_f32 v47, v47
    v_smfmac_f32_32x32x32_bf16 v[128:143], v[88:91], v[32:39], v1
    v_exp_f32 v16, v16
    v_exp_f32 v17, v17
    v_exp_f32 v18, v18
    v_smfmac_f32_32x32x32_bf16 v[128:143], v[92:95], v[40:47], v1
    v_exp_f32 v19, v19
    v_exp_f32 v20, v20
    v_mfma_f32_32x32x16_bf16 v[32:47], v[84:87], v[104:107], 0
    v_exp_f32 v21, v21
    v_exp_f32 v22, v22
    v_exp_f32 v23, v23
    v_exp_f32 v24, v24
    v_exp_f32 v25, v25
    v_exp_f32 v26, v26
    v_exp_f32 v27, v27
    v_exp_f32 v28, v28
    v_exp_f32 v29, v29
    v_exp_f32 v30, v30
    v_exp_f32 v31, v31
    v_smfmac_f32_32x32x32_bf16 v[144:159], v[88:91], v[16:23], v1
    v_exp_f32 v32, v32
    v_exp_f32 v33, v33
    v_exp_f32 v34, v34
    v_smfmac_f32_32x32x32_bf16 v[144:159], v[92:95], v[24:31], v1
    v_exp_f32 v35, v35
    v_exp_f32 v36, v36
    v_mfma_f32_32x32x16_bf16 v[16:31], v[84:87], v[108:111], 0
    v_exp_f32 v37, v37
    v_exp_f32 v38, v38
    v_exp_f32 v39, v39
    v_exp_f32 v40, v40
    v_exp_f32 v41, v41
    v_exp_f32 v42, v42
    v_exp_f32 v43, v43
    v_exp_f32 v44, v44
    v_exp_f32 v45, v45
    v_exp_f32 v46, v46
    v_exp_f32 v47, v47
    v_smfmac_f32_32x32x32_bf16 v[160:175], v[88:91], v[32:39], v1
    v_exp_f32 v16, v16
    v_exp_f32 v17, v17
    v_exp_f32 v18, v18
    v_smfmac_f32_32x32x32_bf16 v[160:175], v[92:95], v[40:47], v1
    v_exp_f32 v19, v19
    v_exp_f32 v20, v20
    v_mfma_f32_32x32x16_bf16 v[32:47], v[84:87], v[112:115], 0
    v_exp_f32 v21, v21
    v_exp_f32 v22, v22
    v_exp_f32 v23, v23
    v_exp_f32 v24, v24
    v_exp_f32 v25, v25
    v_exp_f32 v26, v26
    v_exp_f32 v27, v27
    v_exp_f32 v28, v28
    v_exp_f32 v29, v29
    v_exp_f32 v30, v30
    v_exp_f32 v31, v31
    v_smfmac_f32_32x32x32_bf16 v[176:191], v[88:91], v[16:23], v1
    v_exp_f32 v32, v32
    v_exp_f32 v33, v33
    v_exp_f32 v34, v34
    v_smfmac_f32_32x32x32_bf16 v[176:191], v[92:95], v[24:31], v1
    v_exp_f32 v35, v35
    v_exp_f32 v36, v36
    v_mfma_f32_32x32x16_bf16 v[16:31], v[84:87], v[116:119], 0
    v_exp_f32 v37, v37
    v_exp_f32 v38, v38
    v_exp_f32 v39, v39
    v_exp_f32 v40, v40
    v_exp_f32 v41, v41
    v_exp_f32 v42, v42
    v_exp_f32 v43, v43
    v_exp_f32 v44, v44
    v_exp_f32 v45, v45
    v_exp_f32 v46, v46
    v_exp_f32 v47, v47
    v_smfmac_f32_32x32x32_bf16 v[192:207], v[88:91], v[32:39], v1
    v_exp_f32 v16, v16
    v_exp_f32 v17, v17
    v_exp_f32 v18, v18
    v_smfmac_f32_32x32x32_bf16 v[192:207], v[92:95], v[40:47], v1
    v_exp_f32 v19, v19
    v_exp_f32 v20, v20
    v_mfma_f32_32x32x16_bf16 v[32:47], v[84:87], v[120:123], 0
    v_exp_f32 v21, v21
    v_exp_f32 v22, v22
    v_exp_f32 v23, v23
    v_exp_f32 v24, v24
    v_exp_f32 v25, v25
    v_exp_f32 v26, v26
    v_exp_f32 v27, v27
    v_exp_f32 v28, v28
    v_exp_f32 v29, v29
    v_exp_f32 v30, v30
    v_exp_f32 v31, v31
    v_smfmac_f32_32x32x32_bf16 v[208:223], v[88:91], v[16:23], v1
    v_exp_f32 v32, v32
    v_exp_f32 v33, v33
    v_exp_f32 v34, v34
    v_smfmac_f32_32x32x32_bf16 v[208:223], v[92:95], v[24:31], v1
    v_exp_f32 v35, v35
    v_exp_f32 v36, v36
    v_mfma_f32_32x32x16_bf16 v[16:31], v[84:87], v[124:127], 0
    v_exp_f32 v37, v37
    v_exp_f32 v38, v38
    v_exp_f32 v39, v39
    v_exp_f32 v40, v40
    v_exp_f32 v41, v41
    v_exp_f32 v42, v42
    v_exp_f32 v43, v43
    v_exp_f32 v44, v44
    v_exp_f32 v45, v45
    v_exp_f32 v46, v46
    v_exp_f32 v47, v47
    v_smfmac_f32_32x32x32_bf16 v[224:239], v[88:91], v[32:39], v1
    v_exp_f32 v16, v16
    v_exp_f32 v17, v17
    v_exp_f32 v18, v18
    v_smfmac_f32_32x32x32_bf16 v[224:239], v[92:95], v[40:47], v1
    v_exp_f32 v19, v19
    v_exp_f32 v20, v20
    v_mfma_f32_32x32x16_bf16 v[32:47], v[48:51], v[96:99], 0
    v_exp_f32 v21, v21
    v_exp_f32 v22, v22
    v_exp_f32 v23, v23
    v_exp_f32 v24, v24
    v_exp_f32 v25, v25
    v_exp_f32 v26, v26
    v_exp_f32 v27, v27
    v_exp_f32 v28, v28
    v_exp_f32 v29, v29
    v_exp_f32 v30, v30
    v_exp_f32 v31, v31
    v_smfmac_f32_32x32x32_bf16 v[240:255], v[88:91], v[16:23], v1
    v_exp_f32 v32, v32
    v_exp_f32 v33, v33
    v_exp_f32 v34, v34
    v_smfmac_f32_32x32x32_bf16 v[240:255], v[92:95], v[24:31], v1
    v_exp_f32 v35, v35
    v_exp_f32 v36, v36
    v_mfma_f32_32x32x16_bf16 v[16:31], v[48:51], v[100:103], 0
    v_exp_f32 v37, v37
    buffer_load_dwordx4 v[84:87], v2, s[44:47], s64 offen offset:2048 sc1
    buffer_load_dwordx4 v[88:91], v3, s[44:47], s64 offen offset:3072 sc1
    buffer_load_dwordx4 v[92:95], v3, s[44:47], s64 offen offset:3584 sc1
    s_waitcnt vmcnt(6)
    v_exp_f32 v38, v38
    v_exp_f32 v39, v39
    v_exp_f32 v40, v40
    v_exp_f32 v41, v41
    v_exp_f32 v42, v42
    v_exp_f32 v43, v43
    v_exp_f32 v44, v44
    v_exp_f32 v45, v45
    v_exp_f32 v46, v46
    v_exp_f32 v47, v47
    v_smfmac_f32_32x32x32_bf16 v[128:143], v[52:55], v[32:39], v1
    v_exp_f32 v16, v16
    v_exp_f32 v17, v17
    v_exp_f32 v18, v18
    v_smfmac_f32_32x32x32_bf16 v[128:143], v[56:59], v[40:47], v1
    v_exp_f32 v19, v19
    v_exp_f32 v20, v20
    v_mfma_f32_32x32x16_bf16 v[32:47], v[48:51], v[104:107], 0
    v_exp_f32 v21, v21
    v_exp_f32 v22, v22
    v_exp_f32 v23, v23
    v_exp_f32 v24, v24
    v_exp_f32 v25, v25
    v_exp_f32 v26, v26
    v_exp_f32 v27, v27
    v_exp_f32 v28, v28
    v_exp_f32 v29, v29
    v_exp_f32 v30, v30
    v_exp_f32 v31, v31
    v_smfmac_f32_32x32x32_bf16 v[144:159], v[52:55], v[16:23], v1
    v_exp_f32 v32, v32
    v_exp_f32 v33, v33
    v_exp_f32 v34, v34
    v_smfmac_f32_32x32x32_bf16 v[144:159], v[56:59], v[24:31], v1
    v_exp_f32 v35, v35
    v_exp_f32 v36, v36
    v_mfma_f32_32x32x16_bf16 v[16:31], v[48:51], v[108:111], 0
    v_exp_f32 v37, v37
    v_exp_f32 v38, v38
    v_exp_f32 v39, v39
    v_exp_f32 v40, v40
    v_exp_f32 v41, v41
    v_exp_f32 v42, v42
    v_exp_f32 v43, v43
    v_exp_f32 v44, v44
    v_exp_f32 v45, v45
    v_exp_f32 v46, v46
    v_exp_f32 v47, v47
    v_smfmac_f32_32x32x32_bf16 v[160:175], v[52:55], v[32:39], v1
    v_exp_f32 v16, v16
    v_exp_f32 v17, v17
    v_exp_f32 v18, v18
    v_smfmac_f32_32x32x32_bf16 v[160:175], v[56:59], v[40:47], v1
    v_exp_f32 v19, v19
    v_exp_f32 v20, v20
    v_mfma_f32_32x32x16_bf16 v[32:47], v[48:51], v[112:115], 0
    v_exp_f32 v21, v21
    v_exp_f32 v22, v22
    v_exp_f32 v23, v23
    v_exp_f32 v24, v24
    v_exp_f32 v25, v25
    v_exp_f32 v26, v26
    v_exp_f32 v27, v27
    v_exp_f32 v28, v28
    v_exp_f32 v29, v29
    v_exp_f32 v30, v30
    v_exp_f32 v31, v31
    v_smfmac_f32_32x32x32_bf16 v[176:191], v[52:55], v[16:23], v1
    v_exp_f32 v32, v32
    v_exp_f32 v33, v33
    v_exp_f32 v34, v34
    v_smfmac_f32_32x32x32_bf16 v[176:191], v[56:59], v[24:31], v1
    v_exp_f32 v35, v35
    v_exp_f32 v36, v36
    v_mfma_f32_32x32x16_bf16 v[16:31], v[48:51], v[116:119], 0
    v_exp_f32 v37, v37
    v_exp_f32 v38, v38
    v_exp_f32 v39, v39
    v_exp_f32 v40, v40
    v_exp_f32 v41, v41
    v_exp_f32 v42, v42
    v_exp_f32 v43, v43
    v_exp_f32 v44, v44
    v_exp_f32 v45, v45
    v_exp_f32 v46, v46
    v_exp_f32 v47, v47
    v_smfmac_f32_32x32x32_bf16 v[192:207], v[52:55], v[32:39], v1
    v_exp_f32 v16, v16
    v_exp_f32 v17, v17
    v_exp_f32 v18, v18
    v_smfmac_f32_32x32x32_bf16 v[192:207], v[56:59], v[40:47], v1
    v_exp_f32 v19, v19
    v_exp_f32 v20, v20
    v_mfma_f32_32x32x16_bf16 v[32:47], v[48:51], v[120:123], 0
    v_exp_f32 v21, v21
    v_exp_f32 v22, v22
    v_exp_f32 v23, v23
    v_exp_f32 v24, v24
    v_exp_f32 v25, v25
    v_exp_f32 v26, v26
    v_exp_f32 v27, v27
    v_exp_f32 v28, v28
    v_exp_f32 v29, v29
    v_exp_f32 v30, v30
    v_exp_f32 v31, v31
    v_smfmac_f32_32x32x32_bf16 v[208:223], v[52:55], v[16:23], v1
    v_exp_f32 v32, v32
    v_exp_f32 v33, v33
    v_exp_f32 v34, v34
    v_smfmac_f32_32x32x32_bf16 v[208:223], v[56:59], v[24:31], v1
    v_exp_f32 v35, v35
    v_exp_f32 v36, v36
    v_mfma_f32_32x32x16_bf16 v[16:31], v[48:51], v[124:127], 0
    v_exp_f32 v37, v37
    v_exp_f32 v38, v38
    v_exp_f32 v39, v39
    v_exp_f32 v40, v40
    v_exp_f32 v41, v41
    v_exp_f32 v42, v42
    v_exp_f32 v43, v43
    v_exp_f32 v44, v44
    v_exp_f32 v45, v45
    v_exp_f32 v46, v46
    v_exp_f32 v47, v47
    v_smfmac_f32_32x32x32_bf16 v[224:239], v[52:55], v[32:39], v1
    v_exp_f32 v16, v16
    v_exp_f32 v17, v17
    v_exp_f32 v18, v18
    v_smfmac_f32_32x32x32_bf16 v[224:239], v[56:59], v[40:47], v1
    v_exp_f32 v19, v19
    v_exp_f32 v20, v20
    v_mfma_f32_32x32x16_bf16 v[32:47], v[60:63], v[96:99], 0
    v_exp_f32 v21, v21
    v_exp_f32 v22, v22
    v_exp_f32 v23, v23
    v_exp_f32 v24, v24
    v_exp_f32 v25, v25
    v_exp_f32 v26, v26
    v_exp_f32 v27, v27
    v_exp_f32 v28, v28
    v_exp_f32 v29, v29
    v_exp_f32 v30, v30
    v_exp_f32 v31, v31
    v_smfmac_f32_32x32x32_bf16 v[240:255], v[52:55], v[16:23], v1
    v_exp_f32 v32, v32
    v_exp_f32 v33, v33
    v_exp_f32 v34, v34
    v_smfmac_f32_32x32x32_bf16 v[240:255], v[56:59], v[24:31], v1
    v_exp_f32 v35, v35
    v_exp_f32 v36, v36
    v_mfma_f32_32x32x16_bf16 v[16:31], v[60:63], v[100:103], 0
    v_exp_f32 v37, v37
    buffer_load_dwordx4 v[48:51], v2, s[44:47], s65 offen offset:0 sc1
    buffer_load_dwordx4 v[52:55], v3, s[44:47], s65 offen offset:1024 sc1
    buffer_load_dwordx4 v[56:59], v3, s[44:47], s65 offen offset:1536 sc1
    s_waitcnt vmcnt(6)
    v_exp_f32 v38, v38
    v_exp_f32 v39, v39
    v_exp_f32 v40, v40
    v_exp_f32 v41, v41
    v_exp_f32 v42, v42
    v_exp_f32 v43, v43
    v_exp_f32 v44, v44
    v_exp_f32 v45, v45
    v_exp_f32 v46, v46
    v_exp_f32 v47, v47
    v_smfmac_f32_32x32x32_bf16 v[128:143], v[64:67], v[32:39], v1
    v_exp_f32 v16, v16
    v_exp_f32 v17, v17
    v_exp_f32 v18, v18
    v_smfmac_f32_32x32x32_bf16 v[128:143], v[68:71], v[40:47], v1
    v_exp_f32 v19, v19
    v_exp_f32 v20, v20
    v_mfma_f32_32x32x16_bf16 v[32:47], v[60:63], v[104:107], 0
    v_exp_f32 v21, v21
    v_exp_f32 v22, v22
    v_exp_f32 v23, v23
    v_exp_f32 v24, v24
    v_exp_f32 v25, v25
    v_exp_f32 v26, v26
    v_exp_f32 v27, v27
    v_exp_f32 v28, v28
    v_exp_f32 v29, v29
    v_exp_f32 v30, v30
    v_exp_f32 v31, v31
    v_smfmac_f32_32x32x32_bf16 v[144:159], v[64:67], v[16:23], v1
    v_exp_f32 v32, v32
    v_exp_f32 v33, v33
    v_exp_f32 v34, v34
    v_smfmac_f32_32x32x32_bf16 v[144:159], v[68:71], v[24:31], v1
    v_exp_f32 v35, v35
    v_exp_f32 v36, v36
    v_mfma_f32_32x32x16_bf16 v[16:31], v[60:63], v[108:111], 0
    v_exp_f32 v37, v37
    v_exp_f32 v38, v38
    v_exp_f32 v39, v39
    v_exp_f32 v40, v40
    v_exp_f32 v41, v41
    v_exp_f32 v42, v42
    v_exp_f32 v43, v43
    v_exp_f32 v44, v44
    v_exp_f32 v45, v45
    v_exp_f32 v46, v46
    v_exp_f32 v47, v47
    v_smfmac_f32_32x32x32_bf16 v[160:175], v[64:67], v[32:39], v1
    v_exp_f32 v16, v16
    v_exp_f32 v17, v17
    v_exp_f32 v18, v18
    v_smfmac_f32_32x32x32_bf16 v[160:175], v[68:71], v[40:47], v1
    v_exp_f32 v19, v19
    v_exp_f32 v20, v20
    v_mfma_f32_32x32x16_bf16 v[32:47], v[60:63], v[112:115], 0
    v_exp_f32 v21, v21
    v_exp_f32 v22, v22
    v_exp_f32 v23, v23
    v_exp_f32 v24, v24
    v_exp_f32 v25, v25
    v_exp_f32 v26, v26
    v_exp_f32 v27, v27
    v_exp_f32 v28, v28
    v_exp_f32 v29, v29
    v_exp_f32 v30, v30
    v_exp_f32 v31, v31
    v_smfmac_f32_32x32x32_bf16 v[176:191], v[64:67], v[16:23], v1
    v_exp_f32 v32, v32
    v_exp_f32 v33, v33
    v_exp_f32 v34, v34
    v_smfmac_f32_32x32x32_bf16 v[176:191], v[68:71], v[24:31], v1
    v_exp_f32 v35, v35
    v_exp_f32 v36, v36
    v_mfma_f32_32x32x16_bf16 v[16:31], v[60:63], v[116:119], 0
    v_exp_f32 v37, v37
    v_exp_f32 v38, v38
    v_exp_f32 v39, v39
    v_exp_f32 v40, v40
    v_exp_f32 v41, v41
    v_exp_f32 v42, v42
    v_exp_f32 v43, v43
    v_exp_f32 v44, v44
    v_exp_f32 v45, v45
    v_exp_f32 v46, v46
    v_exp_f32 v47, v47
    v_smfmac_f32_32x32x32_bf16 v[192:207], v[64:67], v[32:39], v1
    v_exp_f32 v16, v16
    v_exp_f32 v17, v17
    v_exp_f32 v18, v18
    v_smfmac_f32_32x32x32_bf16 v[192:207], v[68:71], v[40:47], v1
    v_exp_f32 v19, v19
    v_exp_f32 v20, v20
    v_mfma_f32_32x32x16_bf16 v[32:47], v[60:63], v[120:123], 0
    v_exp_f32 v21, v21
    v_exp_f32 v22, v22
    v_exp_f32 v23, v23
    v_exp_f32 v24, v24
    v_exp_f32 v25, v25
    v_exp_f32 v26, v26
    v_exp_f32 v27, v27
    v_exp_f32 v28, v28
    v_exp_f32 v29, v29
    v_exp_f32 v30, v30
    v_exp_f32 v31, v31
    v_smfmac_f32_32x32x32_bf16 v[208:223], v[64:67], v[16:23], v1
    v_exp_f32 v32, v32
    v_exp_f32 v33, v33
    v_exp_f32 v34, v34
    v_smfmac_f32_32x32x32_bf16 v[208:223], v[68:71], v[24:31], v1
    v_exp_f32 v35, v35
    v_exp_f32 v36, v36
    v_mfma_f32_32x32x16_bf16 v[16:31], v[60:63], v[124:127], 0
    v_exp_f32 v37, v37
    v_exp_f32 v38, v38
    v_exp_f32 v39, v39
    v_exp_f32 v40, v40
    v_exp_f32 v41, v41
    v_exp_f32 v42, v42
    v_exp_f32 v43, v43
    v_exp_f32 v44, v44
    v_exp_f32 v45, v45
    v_exp_f32 v46, v46
    v_exp_f32 v47, v47
    v_smfmac_f32_32x32x32_bf16 v[224:239], v[64:67], v[32:39], v1
    v_exp_f32 v16, v16
    v_exp_f32 v17, v17
    v_exp_f32 v18, v18
    v_smfmac_f32_32x32x32_bf16 v[224:239], v[68:71], v[40:47], v1
    v_exp_f32 v19, v19
    v_exp_f32 v20, v20
    v_mfma_f32_32x32x16_bf16 v[32:47], v[72:75], v[96:99], 0
    v_exp_f32 v21, v21
    v_exp_f32 v22, v22
    v_exp_f32 v23, v23
    v_exp_f32 v24, v24
    v_exp_f32 v25, v25
    v_exp_f32 v26, v26
    v_exp_f32 v27, v27
    v_exp_f32 v28, v28
    v_exp_f32 v29, v29
    v_exp_f32 v30, v30
    v_exp_f32 v31, v31
    v_smfmac_f32_32x32x32_bf16 v[240:255], v[64:67], v[16:23], v1
    v_exp_f32 v32, v32
    v_exp_f32 v33, v33
    v_exp_f32 v34, v34
    v_smfmac_f32_32x32x32_bf16 v[240:255], v[68:71], v[24:31], v1
    v_exp_f32 v35, v35
    v_exp_f32 v36, v36
    v_mfma_f32_32x32x16_bf16 v[16:31], v[72:75], v[100:103], 0
    v_exp_f32 v37, v37
    buffer_load_dwordx4 v[60:63], v2, s[44:47], s65 offen offset:2048 sc1
    buffer_load_dwordx4 v[64:67], v3, s[44:47], s65 offen offset:3072 sc1
    buffer_load_dwordx4 v[68:71], v3, s[44:47], s65 offen offset:3584 sc1
    s_waitcnt vmcnt(6)
    v_exp_f32 v38, v38
    v_exp_f32 v39, v39
    v_exp_f32 v40, v40
    v_exp_f32 v41, v41
    v_exp_f32 v42, v42
    v_exp_f32 v43, v43
    v_exp_f32 v44, v44
    v_exp_f32 v45, v45
    v_exp_f32 v46, v46
    v_exp_f32 v47, v47
    v_smfmac_f32_32x32x32_bf16 v[128:143], v[76:79], v[32:39], v1
    v_exp_f32 v16, v16
    v_exp_f32 v17, v17
    v_exp_f32 v18, v18
    v_smfmac_f32_32x32x32_bf16 v[128:143], v[80:83], v[40:47], v1
    v_exp_f32 v19, v19
    v_exp_f32 v20, v20
    v_mfma_f32_32x32x16_bf16 v[32:47], v[72:75], v[104:107], 0
    v_exp_f32 v21, v21
    v_exp_f32 v22, v22
    v_exp_f32 v23, v23
    v_exp_f32 v24, v24
    v_exp_f32 v25, v25
    v_exp_f32 v26, v26
    v_exp_f32 v27, v27
    v_exp_f32 v28, v28
    v_exp_f32 v29, v29
    v_exp_f32 v30, v30
    v_exp_f32 v31, v31
    v_smfmac_f32_32x32x32_bf16 v[144:159], v[76:79], v[16:23], v1
    v_exp_f32 v32, v32
    v_exp_f32 v33, v33
    v_exp_f32 v34, v34
    v_smfmac_f32_32x32x32_bf16 v[144:159], v[80:83], v[24:31], v1
    v_exp_f32 v35, v35
    v_exp_f32 v36, v36
    v_mfma_f32_32x32x16_bf16 v[16:31], v[72:75], v[108:111], 0
    v_exp_f32 v37, v37
    v_exp_f32 v38, v38
    v_exp_f32 v39, v39
    v_exp_f32 v40, v40
    v_exp_f32 v41, v41
    v_exp_f32 v42, v42
    v_exp_f32 v43, v43
    v_exp_f32 v44, v44
    v_exp_f32 v45, v45
    v_exp_f32 v46, v46
    v_exp_f32 v47, v47
    v_smfmac_f32_32x32x32_bf16 v[160:175], v[76:79], v[32:39], v1
    v_exp_f32 v16, v16
    v_exp_f32 v17, v17
    v_exp_f32 v18, v18
    v_smfmac_f32_32x32x32_bf16 v[160:175], v[80:83], v[40:47], v1
    v_exp_f32 v19, v19
    v_exp_f32 v20, v20
    v_mfma_f32_32x32x16_bf16 v[32:47], v[72:75], v[112:115], 0
    v_exp_f32 v21, v21
    v_exp_f32 v22, v22
    v_exp_f32 v23, v23
    v_exp_f32 v24, v24
    v_exp_f32 v25, v25
    v_exp_f32 v26, v26
    v_exp_f32 v27, v27
    v_exp_f32 v28, v28
    v_exp_f32 v29, v29
    v_exp_f32 v30, v30
    v_exp_f32 v31, v31
    v_smfmac_f32_32x32x32_bf16 v[176:191], v[76:79], v[16:23], v1
    v_exp_f32 v32, v32
    v_exp_f32 v33, v33
    v_smfmac_f32_32x32x32_bf16 v[176:191], v[80:83], v[24:31], v1
    v_exp_f32 v34, v34
    v_exp_f32 v35, v35
    v_exp_f32 v36, v36
    v_mfma_f32_32x32x16_bf16 v[16:31], v[72:75], v[116:119], 0
    v_exp_f32 v37, v37
    v_exp_f32 v38, v38
    v_exp_f32 v39, v39
    v_exp_f32 v40, v40
    v_exp_f32 v41, v41
    v_exp_f32 v42, v42
    v_exp_f32 v43, v43
    v_exp_f32 v44, v44
    v_exp_f32 v45, v45
    v_exp_f32 v46, v46
    v_smfmac_f32_32x32x32_bf16 v[192:207], v[76:79], v[32:39], v1
    v_exp_f32 v47, v47
    v_exp_f32 v16, v16
    v_exp_f32 v17, v17
    v_smfmac_f32_32x32x32_bf16 v[192:207], v[80:83], v[40:47], v1
    v_exp_f32 v18, v18
    v_exp_f32 v19, v19
    v_exp_f32 v20, v20
    v_mfma_f32_32x32x16_bf16 v[32:47], v[72:75], v[120:123], 0
    v_exp_f32 v21, v21
    v_exp_f32 v22, v22
    v_exp_f32 v23, v23
    v_exp_f32 v24, v24
    v_exp_f32 v25, v25
    v_exp_f32 v26, v26
    v_exp_f32 v27, v27
    v_exp_f32 v28, v28
    v_exp_f32 v29, v29
    v_exp_f32 v30, v30
    v_smfmac_f32_32x32x32_bf16 v[208:223], v[76:79], v[16:23], v1
    v_exp_f32 v31, v31
    v_exp_f32 v32, v32
    v_exp_f32 v33, v33
    v_smfmac_f32_32x32x32_bf16 v[208:223], v[80:83], v[24:31], v1
    v_exp_f32 v34, v34
    v_exp_f32 v35, v35
    v_exp_f32 v36, v36
    v_mfma_f32_32x32x16_bf16 v[16:31], v[72:75], v[124:127], 0
    v_exp_f32 v37, v37
    v_exp_f32 v38, v38
    v_exp_f32 v39, v39
    v_exp_f32 v40, v40
    v_exp_f32 v41, v41
    v_exp_f32 v42, v42
    v_exp_f32 v43, v43
    v_exp_f32 v44, v44
    v_exp_f32 v45, v45
    v_exp_f32 v46, v46
    v_smfmac_f32_32x32x32_bf16 v[224:239], v[76:79], v[32:39], v1
    v_exp_f32 v47, v47
    v_exp_f32 v16, v16
    v_exp_f32 v17, v17
    v_smfmac_f32_32x32x32_bf16 v[224:239], v[80:83], v[40:47], v1
    v_exp_f32 v18, v18
    v_exp_f32 v19, v19
    v_exp_f32 v20, v20
    v_mfma_f32_32x32x16_bf16 v[32:47], v[84:87], v[96:99], 0
    v_exp_f32 v21, v21
    v_exp_f32 v22, v22
    v_exp_f32 v23, v23
    v_exp_f32 v24, v24
    v_exp_f32 v25, v25
    v_exp_f32 v26, v26
    v_exp_f32 v27, v27
    v_exp_f32 v28, v28
    v_exp_f32 v29, v29
    v_exp_f32 v30, v30
    v_smfmac_f32_32x32x32_bf16 v[240:255], v[76:79], v[16:23], v1
    v_exp_f32 v31, v31
    v_exp_f32 v32, v32
    v_exp_f32 v33, v33
    v_smfmac_f32_32x32x32_bf16 v[240:255], v[80:83], v[24:31], v1
    v_exp_f32 v34, v34
    v_exp_f32 v35, v35
    v_exp_f32 v36, v36
    v_mfma_f32_32x32x16_bf16 v[16:31], v[84:87], v[100:103], 0
    v_exp_f32 v37, v37
    v_exp_f32 v38, v38
    buffer_load_dwordx4 v[72:75], v2, s[44:47], s66 offen offset:0 sc1
    buffer_load_dwordx4 v[76:79], v3, s[44:47], s66 offen offset:1024 sc1
    buffer_load_dwordx4 v[80:83], v3, s[44:47], s66 offen offset:1536 sc1
    s_waitcnt vmcnt(6)
    v_exp_f32 v39, v39
    v_exp_f32 v40, v40
    v_exp_f32 v41, v41
    v_exp_f32 v42, v42
    v_exp_f32 v43, v43
    v_exp_f32 v44, v44
    v_exp_f32 v45, v45
    v_exp_f32 v46, v46
    v_smfmac_f32_32x32x32_bf16 v[128:143], v[88:91], v[32:39], v1
    v_exp_f32 v47, v47
    v_exp_f32 v16, v16
    v_exp_f32 v17, v17
    v_smfmac_f32_32x32x32_bf16 v[128:143], v[92:95], v[40:47], v1
    v_exp_f32 v18, v18
    v_exp_f32 v19, v19
    v_exp_f32 v20, v20
    v_mfma_f32_32x32x16_bf16 v[32:47], v[84:87], v[104:107], 0
    v_exp_f32 v21, v21
    v_exp_f32 v22, v22
    v_exp_f32 v23, v23
    v_exp_f32 v24, v24
    v_exp_f32 v25, v25
    v_exp_f32 v26, v26
    v_exp_f32 v27, v27
    v_exp_f32 v28, v28
    v_exp_f32 v29, v29
    v_exp_f32 v30, v30
    v_smfmac_f32_32x32x32_bf16 v[144:159], v[88:91], v[16:23], v1
    v_exp_f32 v31, v31
    v_exp_f32 v32, v32
    v_exp_f32 v33, v33
    v_smfmac_f32_32x32x32_bf16 v[144:159], v[92:95], v[24:31], v1
    v_exp_f32 v34, v34
    v_exp_f32 v35, v35
    v_exp_f32 v36, v36
    v_mfma_f32_32x32x16_bf16 v[16:31], v[84:87], v[108:111], 0
    v_exp_f32 v37, v37
    v_exp_f32 v38, v38
    v_exp_f32 v39, v39
    v_exp_f32 v40, v40
    v_exp_f32 v41, v41
    v_exp_f32 v42, v42
    v_exp_f32 v43, v43
    v_exp_f32 v44, v44
    v_exp_f32 v45, v45
    v_exp_f32 v46, v46
    v_smfmac_f32_32x32x32_bf16 v[160:175], v[88:91], v[32:39], v1
    v_exp_f32 v47, v47
    v_exp_f32 v16, v16
    v_exp_f32 v17, v17
    v_smfmac_f32_32x32x32_bf16 v[160:175], v[92:95], v[40:47], v1
    v_exp_f32 v18, v18
    v_exp_f32 v19, v19
    v_exp_f32 v20, v20
    v_mfma_f32_32x32x16_bf16 v[32:47], v[84:87], v[112:115], 0
    v_exp_f32 v21, v21
    v_exp_f32 v22, v22
    v_exp_f32 v23, v23
    v_exp_f32 v24, v24
    v_exp_f32 v25, v25
    v_exp_f32 v26, v26
    v_exp_f32 v27, v27
    v_exp_f32 v28, v28
    v_exp_f32 v29, v29
    v_exp_f32 v30, v30
    v_smfmac_f32_32x32x32_bf16 v[176:191], v[88:91], v[16:23], v1
    v_exp_f32 v31, v31
    v_exp_f32 v32, v32
    v_exp_f32 v33, v33
    v_smfmac_f32_32x32x32_bf16 v[176:191], v[92:95], v[24:31], v1
    v_exp_f32 v34, v34
    v_exp_f32 v35, v35
    v_exp_f32 v36, v36
    v_mfma_f32_32x32x16_bf16 v[16:31], v[84:87], v[116:119], 0
    v_exp_f32 v37, v37
    v_exp_f32 v38, v38
    v_exp_f32 v39, v39
    v_exp_f32 v40, v40
    v_exp_f32 v41, v41
    v_exp_f32 v42, v42
    v_exp_f32 v43, v43
    v_exp_f32 v44, v44
    v_exp_f32 v45, v45
    v_exp_f32 v46, v46
    v_smfmac_f32_32x32x32_bf16 v[192:207], v[88:91], v[32:39], v1
    v_exp_f32 v47, v47
    v_exp_f32 v16, v16
    v_exp_f32 v17, v17
    v_smfmac_f32_32x32x32_bf16 v[192:207], v[92:95], v[40:47], v1
    v_exp_f32 v18, v18
    v_exp_f32 v19, v19
    v_exp_f32 v20, v20
    v_mfma_f32_32x32x16_bf16 v[32:47], v[84:87], v[120:123], 0
    v_exp_f32 v21, v21
    v_exp_f32 v22, v22
    v_exp_f32 v23, v23
    v_exp_f32 v24, v24
    v_exp_f32 v25, v25
    v_exp_f32 v26, v26
    v_exp_f32 v27, v27
    v_exp_f32 v28, v28
    v_exp_f32 v29, v29
    v_exp_f32 v30, v30
    v_smfmac_f32_32x32x32_bf16 v[208:223], v[88:91], v[16:23], v1
    v_exp_f32 v31, v31
    v_exp_f32 v32, v32
    v_exp_f32 v33, v33
    v_smfmac_f32_32x32x32_bf16 v[208:223], v[92:95], v[24:31], v1
    v_exp_f32 v34, v34
    v_exp_f32 v35, v35
    v_exp_f32 v36, v36
    v_mfma_f32_32x32x16_bf16 v[16:31], v[84:87], v[124:127], 0
    v_exp_f32 v37, v37
    v_exp_f32 v38, v38
    v_exp_f32 v39, v39
    v_exp_f32 v40, v40
    v_exp_f32 v41, v41
    v_exp_f32 v42, v42
    v_exp_f32 v43, v43
    v_exp_f32 v44, v44
    v_exp_f32 v45, v45
    v_exp_f32 v46, v46
    v_smfmac_f32_32x32x32_bf16 v[224:239], v[88:91], v[32:39], v1
    v_exp_f32 v47, v47
    v_exp_f32 v16, v16
    v_exp_f32 v17, v17
    v_smfmac_f32_32x32x32_bf16 v[224:239], v[92:95], v[40:47], v1
    v_exp_f32 v18, v18
    v_exp_f32 v19, v19
    v_exp_f32 v20, v20
    v_mfma_f32_32x32x16_bf16 v[32:47], v[48:51], v[96:99], 0
    v_exp_f32 v21, v21
    v_exp_f32 v22, v22
    v_exp_f32 v23, v23
    v_exp_f32 v24, v24
    v_exp_f32 v25, v25
    v_exp_f32 v26, v26
    v_exp_f32 v27, v27
    v_exp_f32 v28, v28
    v_exp_f32 v29, v29
    v_exp_f32 v30, v30
    v_smfmac_f32_32x32x32_bf16 v[240:255], v[88:91], v[16:23], v1
    v_exp_f32 v31, v31
    v_exp_f32 v32, v32
    v_exp_f32 v33, v33
    v_smfmac_f32_32x32x32_bf16 v[240:255], v[92:95], v[24:31], v1
    v_exp_f32 v34, v34
    v_exp_f32 v35, v35
    v_exp_f32 v36, v36
    v_mfma_f32_32x32x16_bf16 v[16:31], v[48:51], v[100:103], 0
    v_exp_f32 v37, v37
    v_exp_f32 v38, v38
    buffer_load_dwordx4 v[84:87], v2, s[44:47], s66 offen offset:2048 sc1
    buffer_load_dwordx4 v[88:91], v3, s[44:47], s66 offen offset:3072 sc1
    buffer_load_dwordx4 v[92:95], v3, s[44:47], s66 offen offset:3584 sc1
    s_waitcnt vmcnt(6)
    v_exp_f32 v39, v39
    v_exp_f32 v40, v40
    v_exp_f32 v41, v41
    v_exp_f32 v42, v42
    v_exp_f32 v43, v43
    v_exp_f32 v44, v44
    v_exp_f32 v45, v45
    v_exp_f32 v46, v46
    v_smfmac_f32_32x32x32_bf16 v[128:143], v[52:55], v[32:39], v1
    v_exp_f32 v47, v47
    v_exp_f32 v16, v16
    v_exp_f32 v17, v17
    v_smfmac_f32_32x32x32_bf16 v[128:143], v[56:59], v[40:47], v1
    v_exp_f32 v18, v18
    v_exp_f32 v19, v19
    v_exp_f32 v20, v20
    v_mfma_f32_32x32x16_bf16 v[32:47], v[48:51], v[104:107], 0
    v_exp_f32 v21, v21
    v_exp_f32 v22, v22
    v_exp_f32 v23, v23
    v_exp_f32 v24, v24
    v_exp_f32 v25, v25
    v_exp_f32 v26, v26
    v_exp_f32 v27, v27
    v_exp_f32 v28, v28
    v_exp_f32 v29, v29
    v_exp_f32 v30, v30
    v_smfmac_f32_32x32x32_bf16 v[144:159], v[52:55], v[16:23], v1
    v_exp_f32 v31, v31
    v_exp_f32 v32, v32
    v_exp_f32 v33, v33
    v_smfmac_f32_32x32x32_bf16 v[144:159], v[56:59], v[24:31], v1
    v_exp_f32 v34, v34
    v_exp_f32 v35, v35
    v_exp_f32 v36, v36
    v_mfma_f32_32x32x16_bf16 v[16:31], v[48:51], v[108:111], 0
    v_exp_f32 v37, v37
    v_exp_f32 v38, v38
    v_exp_f32 v39, v39
    v_exp_f32 v40, v40
    v_exp_f32 v41, v41
    v_exp_f32 v42, v42
    v_exp_f32 v43, v43
    v_exp_f32 v44, v44
    v_exp_f32 v45, v45
    v_exp_f32 v46, v46
    v_smfmac_f32_32x32x32_bf16 v[160:175], v[52:55], v[32:39], v1
    v_exp_f32 v47, v47
    v_exp_f32 v16, v16
    v_exp_f32 v17, v17
    v_smfmac_f32_32x32x32_bf16 v[160:175], v[56:59], v[40:47], v1
    v_exp_f32 v18, v18
    v_exp_f32 v19, v19
    v_exp_f32 v20, v20
    v_mfma_f32_32x32x16_bf16 v[32:47], v[48:51], v[112:115], 0
    v_exp_f32 v21, v21
    v_exp_f32 v22, v22
    v_exp_f32 v23, v23
    v_exp_f32 v24, v24
    v_exp_f32 v25, v25
    v_exp_f32 v26, v26
    v_exp_f32 v27, v27
    v_exp_f32 v28, v28
    v_exp_f32 v29, v29
    v_exp_f32 v30, v30
    v_smfmac_f32_32x32x32_bf16 v[176:191], v[52:55], v[16:23], v1
    v_exp_f32 v31, v31
    v_exp_f32 v32, v32
    v_exp_f32 v33, v33
    v_smfmac_f32_32x32x32_bf16 v[176:191], v[56:59], v[24:31], v1
    v_exp_f32 v34, v34
    v_exp_f32 v35, v35
    v_exp_f32 v36, v36
    v_mfma_f32_32x32x16_bf16 v[16:31], v[48:51], v[116:119], 0
    v_exp_f32 v37, v37
    v_exp_f32 v38, v38
    v_exp_f32 v39, v39
    v_exp_f32 v40, v40
    v_exp_f32 v41, v41
    v_exp_f32 v42, v42
    v_exp_f32 v43, v43
    v_exp_f32 v44, v44
    v_exp_f32 v45, v45
    v_exp_f32 v46, v46
    v_smfmac_f32_32x32x32_bf16 v[192:207], v[52:55], v[32:39], v1
    v_exp_f32 v47, v47
    v_exp_f32 v16, v16
    v_exp_f32 v17, v17
    v_smfmac_f32_32x32x32_bf16 v[192:207], v[56:59], v[40:47], v1
    v_exp_f32 v18, v18
    v_exp_f32 v19, v19
    v_exp_f32 v20, v20
    v_mfma_f32_32x32x16_bf16 v[32:47], v[48:51], v[120:123], 0
    v_exp_f32 v21, v21
    v_exp_f32 v22, v22
    v_exp_f32 v23, v23
    v_exp_f32 v24, v24
    v_exp_f32 v25, v25
    v_exp_f32 v26, v26
    v_exp_f32 v27, v27
    v_exp_f32 v28, v28
    v_exp_f32 v29, v29
    v_exp_f32 v30, v30
    v_smfmac_f32_32x32x32_bf16 v[208:223], v[52:55], v[16:23], v1
    v_exp_f32 v31, v31
    v_exp_f32 v32, v32
    v_exp_f32 v33, v33
    v_smfmac_f32_32x32x32_bf16 v[208:223], v[56:59], v[24:31], v1
    v_exp_f32 v34, v34
    v_exp_f32 v35, v35
    v_exp_f32 v36, v36
    v_mfma_f32_32x32x16_bf16 v[16:31], v[48:51], v[124:127], 0
    v_exp_f32 v37, v37
    v_exp_f32 v38, v38
    v_exp_f32 v39, v39
    v_exp_f32 v40, v40
    v_exp_f32 v41, v41
    v_exp_f32 v42, v42
    v_exp_f32 v43, v43
    v_exp_f32 v44, v44
    v_exp_f32 v45, v45
    v_exp_f32 v46, v46
    v_smfmac_f32_32x32x32_bf16 v[224:239], v[52:55], v[32:39], v1
    v_exp_f32 v47, v47
    v_exp_f32 v16, v16
    v_exp_f32 v17, v17
    v_smfmac_f32_32x32x32_bf16 v[224:239], v[56:59], v[40:47], v1
    v_exp_f32 v18, v18
    v_exp_f32 v19, v19
    v_exp_f32 v20, v20
    v_mfma_f32_32x32x16_bf16 v[32:47], v[60:63], v[96:99], 0
    v_exp_f32 v21, v21
    v_exp_f32 v22, v22
    v_exp_f32 v23, v23
    v_exp_f32 v24, v24
    v_exp_f32 v25, v25
    v_exp_f32 v26, v26
    v_exp_f32 v27, v27
    v_exp_f32 v28, v28
    v_exp_f32 v29, v29
    v_exp_f32 v30, v30
    v_smfmac_f32_32x32x32_bf16 v[240:255], v[52:55], v[16:23], v1
    v_exp_f32 v31, v31
    v_exp_f32 v32, v32
    v_exp_f32 v33, v33
    v_smfmac_f32_32x32x32_bf16 v[240:255], v[56:59], v[24:31], v1
    v_exp_f32 v34, v34
    v_exp_f32 v35, v35
    v_exp_f32 v36, v36
    v_mfma_f32_32x32x16_bf16 v[16:31], v[60:63], v[100:103], 0
    v_exp_f32 v37, v37
    v_exp_f32 v38, v38
    buffer_load_dwordx4 v[48:51], v2, s[44:47], s67 offen offset:0 sc1
    buffer_load_dwordx4 v[52:55], v3, s[44:47], s67 offen offset:1024 sc1
    buffer_load_dwordx4 v[56:59], v3, s[44:47], s67 offen offset:1536 sc1
    s_waitcnt vmcnt(6)
    v_exp_f32 v39, v39
    v_exp_f32 v40, v40
    v_exp_f32 v41, v41
    v_exp_f32 v42, v42
    v_exp_f32 v43, v43
    v_exp_f32 v44, v44
    v_exp_f32 v45, v45
    v_exp_f32 v46, v46
    v_smfmac_f32_32x32x32_bf16 v[128:143], v[64:67], v[32:39], v1
    v_exp_f32 v47, v47
    v_exp_f32 v16, v16
    v_exp_f32 v17, v17
    v_smfmac_f32_32x32x32_bf16 v[128:143], v[68:71], v[40:47], v1
    v_exp_f32 v18, v18
    v_exp_f32 v19, v19
    v_exp_f32 v20, v20
    v_mfma_f32_32x32x16_bf16 v[32:47], v[60:63], v[104:107], 0
    v_exp_f32 v21, v21
    v_exp_f32 v22, v22
    v_exp_f32 v23, v23
    v_exp_f32 v24, v24
    v_exp_f32 v25, v25
    v_exp_f32 v26, v26
    v_exp_f32 v27, v27
    v_exp_f32 v28, v28
    v_exp_f32 v29, v29
    v_exp_f32 v30, v30
    v_smfmac_f32_32x32x32_bf16 v[144:159], v[64:67], v[16:23], v1
    v_exp_f32 v31, v31
    v_exp_f32 v32, v32
    v_exp_f32 v33, v33
    v_smfmac_f32_32x32x32_bf16 v[144:159], v[68:71], v[24:31], v1
    v_exp_f32 v34, v34
    v_exp_f32 v35, v35
    v_exp_f32 v36, v36
    v_mfma_f32_32x32x16_bf16 v[16:31], v[60:63], v[108:111], 0
    v_exp_f32 v37, v37
    v_exp_f32 v38, v38
    v_exp_f32 v39, v39
    v_exp_f32 v40, v40
    v_exp_f32 v41, v41
    v_exp_f32 v42, v42
    v_exp_f32 v43, v43
    v_exp_f32 v44, v44
    v_exp_f32 v45, v45
    v_exp_f32 v46, v46
    v_smfmac_f32_32x32x32_bf16 v[160:175], v[64:67], v[32:39], v1
    v_exp_f32 v47, v47
    v_exp_f32 v16, v16
    v_exp_f32 v17, v17
    v_smfmac_f32_32x32x32_bf16 v[160:175], v[68:71], v[40:47], v1
    v_exp_f32 v18, v18
    v_exp_f32 v19, v19
    v_exp_f32 v20, v20
    v_mfma_f32_32x32x16_bf16 v[32:47], v[60:63], v[112:115], 0
    v_exp_f32 v21, v21
    v_exp_f32 v22, v22
    v_exp_f32 v23, v23
    v_exp_f32 v24, v24
    v_exp_f32 v25, v25
    v_exp_f32 v26, v26
    v_exp_f32 v27, v27
    v_exp_f32 v28, v28
    v_exp_f32 v29, v29
    v_exp_f32 v30, v30
    v_smfmac_f32_32x32x32_bf16 v[176:191], v[64:67], v[16:23], v1
    v_exp_f32 v31, v31
    v_exp_f32 v32, v32
    v_exp_f32 v33, v33
    v_smfmac_f32_32x32x32_bf16 v[176:191], v[68:71], v[24:31], v1
    v_exp_f32 v34, v34
    v_exp_f32 v35, v35
    v_exp_f32 v36, v36
    v_mfma_f32_32x32x16_bf16 v[16:31], v[60:63], v[116:119], 0
    v_exp_f32 v37, v37
    v_exp_f32 v38, v38
    v_exp_f32 v39, v39
    v_exp_f32 v40, v40
    v_exp_f32 v41, v41
    v_exp_f32 v42, v42
    v_exp_f32 v43, v43
    v_exp_f32 v44, v44
    v_exp_f32 v45, v45
    v_exp_f32 v46, v46
    v_smfmac_f32_32x32x32_bf16 v[192:207], v[64:67], v[32:39], v1
    v_exp_f32 v47, v47
    v_exp_f32 v16, v16
    v_exp_f32 v17, v17
    v_smfmac_f32_32x32x32_bf16 v[192:207], v[68:71], v[40:47], v1
    v_exp_f32 v18, v18
    v_exp_f32 v19, v19
    v_exp_f32 v20, v20
    v_mfma_f32_32x32x16_bf16 v[32:47], v[60:63], v[120:123], 0
    v_exp_f32 v21, v21
    v_exp_f32 v22, v22
    v_exp_f32 v23, v23
    v_exp_f32 v24, v24
    v_exp_f32 v25, v25
    v_exp_f32 v26, v26
    v_exp_f32 v27, v27
    v_exp_f32 v28, v28
    v_exp_f32 v29, v29
    v_exp_f32 v30, v30
    v_smfmac_f32_32x32x32_bf16 v[208:223], v[64:67], v[16:23], v1
    v_exp_f32 v31, v31
    v_exp_f32 v32, v32
    v_exp_f32 v33, v33
    v_smfmac_f32_32x32x32_bf16 v[208:223], v[68:71], v[24:31], v1
    v_exp_f32 v34, v34
    v_exp_f32 v35, v35
    v_exp_f32 v36, v36
    v_mfma_f32_32x32x16_bf16 v[16:31], v[60:63], v[124:127], 0
    v_exp_f32 v37, v37
    v_exp_f32 v38, v38
    v_exp_f32 v39, v39
    v_exp_f32 v40, v40
    v_exp_f32 v41, v41
    v_exp_f32 v42, v42
    v_exp_f32 v43, v43
    v_exp_f32 v44, v44
    v_exp_f32 v45, v45
    v_exp_f32 v46, v46
    v_smfmac_f32_32x32x32_bf16 v[224:239], v[64:67], v[32:39], v1
    v_exp_f32 v47, v47
    v_exp_f32 v16, v16
    v_exp_f32 v17, v17
    v_smfmac_f32_32x32x32_bf16 v[224:239], v[68:71], v[40:47], v1
    v_exp_f32 v18, v18
    v_exp_f32 v19, v19
    v_exp_f32 v20, v20
    v_mfma_f32_32x32x16_bf16 v[32:47], v[72:75], v[96:99], 0
    v_exp_f32 v21, v21
    v_exp_f32 v22, v22
    v_exp_f32 v23, v23
    v_exp_f32 v24, v24
    v_exp_f32 v25, v25
    v_exp_f32 v26, v26
    v_exp_f32 v27, v27
    v_exp_f32 v28, v28
    v_exp_f32 v29, v29
    s_waitcnt vmcnt(0)
    v_exp_f32 v30, v30
    v_smfmac_f32_32x32x32_bf16 v[240:255], v[64:67], v[16:23], v1
    v_exp_f32 v31, v31
    v_exp_f32 v32, v32
    v_exp_f32 v33, v33
    v_smfmac_f32_32x32x32_bf16 v[240:255], v[68:71], v[24:31], v1
    v_exp_f32 v34, v34
    v_exp_f32 v35, v35
    v_exp_f32 v36, v36
    v_mfma_f32_32x32x16_bf16 v[16:31], v[84:87], v[96:99], 0
    v_exp_f32 v37, v37
    v_exp_f32 v38, v38
    v_exp_f32 v39, v39
    v_exp_f32 v40, v40
    v_exp_f32 v41, v41
    v_exp_f32 v42, v42
    v_exp_f32 v43, v43
    buffer_load_dwordx4 v[60:63], v2, s[44:47], s67 offen offset:2048 sc1
    buffer_load_dwordx4 v[64:67], v3, s[44:47], s67 offen offset:3072 sc1
    buffer_load_dwordx4 v[68:71], v3, s[44:47], s67 offen offset:3584 sc1
    ds_read_b32 v2, v14 offset:32512
    ds_read_b32 v3, v12 offset:32000
    v_exp_f32 v44, v44
    v_exp_f32 v45, v45
    v_exp_f32 v46, v46
    v_smfmac_f32_32x32x32_bf16 v[128:143], v[76:79], v[32:39], v1
    v_exp_f32 v47, v47
    v_exp_f32 v16, v16
    v_exp_f32 v17, v17
    v_smfmac_f32_32x32x32_bf16 v[128:143], v[80:83], v[40:47], v1
    v_exp_f32 v18, v18
    v_exp_f32 v19, v19
    v_exp_f32 v20, v20
    v_mfma_f32_32x32x16_bf16 v[32:47], v[48:51], v[96:99], 0
    v_exp_f32 v21, v21
    v_exp_f32 v22, v22
    v_exp_f32 v23, v23
    v_exp_f32 v24, v24
    v_exp_f32 v25, v25
    v_exp_f32 v26, v26
    v_exp_f32 v27, v27
    v_exp_f32 v28, v28
    v_exp_f32 v29, v29
    v_exp_f32 v30, v30
    v_smfmac_f32_32x32x32_bf16 v[128:143], v[88:91], v[16:23], v1
    v_exp_f32 v31, v31
    v_exp_f32 v32, v32
    v_exp_f32 v33, v33
    v_smfmac_f32_32x32x32_bf16 v[128:143], v[92:95], v[24:31], v1
    v_exp_f32 v34, v34
    v_exp_f32 v35, v35
    v_exp_f32 v36, v36
    v_mfma_f32_32x32x16_bf16 v[16:31], v[72:75], v[100:103], 0
    v_exp_f32 v37, v37
    v_exp_f32 v38, v38
    v_exp_f32 v39, v39
    v_exp_f32 v40, v40
    v_exp_f32 v41, v41
    v_exp_f32 v42, v42
    v_exp_f32 v43, v43
    v_exp_f32 v44, v44
    v_exp_f32 v45, v45
    v_exp_f32 v46, v46
    v_smfmac_f32_32x32x32_bf16 v[128:143], v[52:55], v[32:39], v1
    v_exp_f32 v47, v47
    v_exp_f32 v16, v16
    v_exp_f32 v17, v17
    v_smfmac_f32_32x32x32_bf16 v[128:143], v[56:59], v[40:47], v1
    v_exp_f32 v18, v18
    v_exp_f32 v19, v19
    v_exp_f32 v20, v20
    v_mfma_f32_32x32x16_bf16 v[32:47], v[84:87], v[100:103], 0
    v_exp_f32 v21, v21
    v_exp_f32 v22, v22
    v_exp_f32 v23, v23
    v_exp_f32 v24, v24
    v_exp_f32 v25, v25
    v_exp_f32 v26, v26
    v_exp_f32 v27, v27
    v_exp_f32 v28, v28
    v_exp_f32 v29, v29
    v_exp_f32 v30, v30
    v_smfmac_f32_32x32x32_bf16 v[144:159], v[76:79], v[16:23], v1
    v_exp_f32 v31, v31
    v_exp_f32 v32, v32
    v_exp_f32 v33, v33
    v_smfmac_f32_32x32x32_bf16 v[144:159], v[80:83], v[24:31], v1
    v_exp_f32 v34, v34
    v_exp_f32 v35, v35
    v_exp_f32 v36, v36
    v_mfma_f32_32x32x16_bf16 v[16:31], v[48:51], v[100:103], 0
    v_exp_f32 v37, v37
    v_exp_f32 v38, v38
    v_exp_f32 v39, v39
    v_exp_f32 v40, v40
    v_exp_f32 v41, v41
    v_exp_f32 v42, v42
    v_exp_f32 v43, v43
    s_waitcnt vmcnt(0) lgkmcnt(0)
    v_cmp_gt_i32 vcc, 2, v2
    s_cbranch_vccnz L_bretry
L_bgot:
    v_exp_f32 v44, v44
    v_exp_f32 v45, v45
    v_exp_f32 v46, v46
    v_smfmac_f32_32x32x32_bf16 v[144:159], v[88:91], v[32:39], v1
    v_exp_f32 v47, v47
    v_exp_f32 v16, v16
    v_exp_f32 v17, v17
    v_smfmac_f32_32x32x32_bf16 v[144:159], v[92:95], v[40:47], v1
    v_exp_f32 v18, v18
    v_exp_f32 v19, v19
    v_exp_f32 v20, v20
    v_mfma_f32_32x32x16_bf16 v[32:47], v[60:63], v[96:99], 0
    v_exp_f32 v21, v21
    v_exp_f32 v22, v22
    v_exp_f32 v23, v23
    v_exp_f32 v24, v24
    v_exp_f32 v25, v25
    v_exp_f32 v26, v26
    v_exp_f32 v27, v27
    v_exp_f32 v28, v28
    v_exp_f32 v29, v29
    v_exp_f32 v30, v30
    v_smfmac_f32_32x32x32_bf16 v[144:159], v[52:55], v[16:23], v1
    v_exp_f32 v31, v31
    v_exp_f32 v32, v32
    v_exp_f32 v33, v33
    v_smfmac_f32_32x32x32_bf16 v[144:159], v[56:59], v[24:31], v1
    v_exp_f32 v34, v34
    v_exp_f32 v35, v35
    v_exp_f32 v36, v36
    v_mfma_f32_32x32x16_bf16 v[16:31], v[60:63], v[100:103], 0
    v_exp_f32 v37, v37
    v_exp_f32 v38, v38
    v_exp_f32 v39, v39
    v_exp_f32 v40, v40
    v_exp_f32 v41, v41
    v_exp_f32 v42, v42
    v_exp_f32 v43, v43
    v_exp_f32 v44, v44
    v_exp_f32 v45, v45
    v_exp_f32 v46, v46
    v_smfmac_f32_32x32x32_bf16 v[128:143], v[64:67], v[32:39], v1
    v_exp_f32 v47, v47
    v_exp_f32 v16, v16
    v_exp_f32 v17, v17
    v_smfmac_f32_32x32x32_bf16 v[128:143], v[68:71], v[40:47], v1
    v_exp_f32 v18, v18
    v_exp_f32 v19, v19
    v_exp_f32 v20, v20
    v_mfma_f32_32x32x16_bf16 v[32:47], v[72:75], v[104:107], 0
    v_exp_f32 v21, v21
    v_exp_f32 v22, v22
    v_exp_f32 v23, v23
    v_exp_f32 v24, v24
    v_exp_f32 v25, v25
    v_exp_f32 v26, v26
    v_exp_f32 v27, v27
    v_exp_f32 v28, v28
    v_exp_f32 v29, v29
    ds_write_b128 v4, v[128:131] offset:0
    ds_write_b128 v4, v[132:135] offset:1024
    ds_write_b32 v5, v136 offset:24832
    v_exp_f32 v30, v30
    v_smfmac_f32_32x32x32_bf16 v[144:159], v[64:67], v[16:23], v1
    v_exp_f32 v31, v31
    v_exp_f32 v32, v32
    v_exp_f32 v33, v33
    v_smfmac_f32_32x32x32_bf16 v[144:159], v[68:71], v[24:31], v1
    v_exp_f32 v34, v34
    v_exp_f32 v35, v35
    v_exp_f32 v36, v36
    v_mfma_f32_32x32x16_bf16 v[16:31], v[84:87], v[104:107], 0
    v_exp_f32 v37, v37
    v_exp_f32 v38, v38
    v_exp_f32 v39, v39
    v_exp_f32 v40, v40
    v_exp_f32 v41, v41
    v_exp_f32 v42, v42
    v_exp_f32 v43, v43
    v_exp_f32 v44, v44
    v_exp_f32 v45, v45
    ds_write_b128 v4, v[144:147] offset:8192
    ds_write_b128 v4, v[148:151] offset:9216
    ds_write_b32 v5, v152 offset:25856
    v_exp_f32 v46, v46
    v_smfmac_f32_32x32x32_bf16 v[160:175], v[76:79], v[32:39], v1
    v_exp_f32 v47, v47
    v_exp_f32 v16, v16
    v_exp_f32 v17, v17
    v_smfmac_f32_32x32x32_bf16 v[160:175], v[80:83], v[40:47], v1
    v_exp_f32 v18, v18
    v_exp_f32 v19, v19
    v_exp_f32 v20, v20
    v_mfma_f32_32x32x16_bf16 v[32:47], v[48:51], v[104:107], 0
    v_exp_f32 v21, v21
    v_exp_f32 v22, v22
    v_exp_f32 v23, v23
    v_exp_f32 v24, v24
    v_exp_f32 v25, v25
    v_exp_f32 v26, v26
    v_exp_f32 v27, v27
    v_exp_f32 v28, v28
    v_exp_f32 v29, v29
    v_exp_f32 v30, v30
    v_smfmac_f32_32x32x32_bf16 v[160:175], v[88:91], v[16:23], v1
    v_exp_f32 v31, v31
    v_exp_f32 v32, v32
    v_exp_f32 v33, v33
    v_smfmac_f32_32x32x32_bf16 v[160:175], v[92:95], v[24:31], v1
    v_exp_f32 v34, v34
    v_exp_f32 v35, v35
    v_exp_f32 v36, v36
    v_mfma_f32_32x32x16_bf16 v[16:31], v[60:63], v[104:107], 0
    v_exp_f32 v37, v37
    v_exp_f32 v38, v38
    v_exp_f32 v39, v39
    v_exp_f32 v40, v40
    v_exp_f32 v41, v41
    v_exp_f32 v42, v42
    v_exp_f32 v43, v43
    v_exp_f32 v44, v44
    v_exp_f32 v45, v45
    v_exp_f32 v46, v46
    v_smfmac_f32_32x32x32_bf16 v[160:175], v[52:55], v[32:39], v1
    v_exp_f32 v47, v47
    v_exp_f32 v16, v16
    v_exp_f32 v17, v17
    v_smfmac_f32_32x32x32_bf16 v[160:175], v[56:59], v[40:47], v1
    v_exp_f32 v18, v18
    v_exp_f32 v19, v19
    v_exp_f32 v20, v20
    v_mfma_f32_32x32x16_bf16 v[32:47], v[72:75], v[108:111], 0
    v_exp_f32 v21, v21
    v_exp_f32 v22, v22
    v_exp_f32 v23, v23
    v_exp_f32 v24, v24
    v_exp_f32 v25, v25
    v_exp_f32 v26, v26
    v_exp_f32 v27, v27
    v_exp_f32 v28, v28
    v_exp_f32 v29, v29
    v_exp_f32 v30, v30
    v_smfmac_f32_32x32x32_bf16 v[160:175], v[64:67], v[16:23], v1
    v_exp_f32 v31, v31
    v_exp_f32 v32, v32
    v_exp_f32 v33, v33
    v_smfmac_f32_32x32x32_bf16 v[160:175], v[68:71], v[24:31], v1
    v_exp_f32 v34, v34
    v_exp_f32 v35, v35
    v_exp_f32 v36, v36
    v_mfma_f32_32x32x16_bf16 v[16:31], v[84:87], v[108:111], 0
    v_exp_f32 v37, v37
    v_exp_f32 v38, v38
    v_exp_f32 v39, v39
    v_exp_f32 v40, v40
    v_exp_f32 v41, v41
    v_exp_f32 v42, v42
    v_exp_f32 v43, v43
    v_exp_f32 v44, v44
    v_exp_f32 v45, v45
    ds_write_b128 v4, v[160:163] offset:16384
    ds_write_b128 v4, v[164:167] offset:17408
    ds_write_b32 v5, v168 offset:26880
    v_exp_f32 v46, v46
    v_smfmac_f32_32x32x32_bf16 v[176:191], v[76:79], v[32:39], v1
    v_exp_f32 v47, v47
    v_exp_f32 v16, v16
    v_exp_f32 v17, v17
    v_smfmac_f32_32x32x32_bf16 v[176:191], v[80:83], v[40:47], v1
    v_exp_f32 v18, v18
    v_exp_f32 v19, v19
    v_exp_f32 v20, v20
    v_mfma_f32_32x32x16_bf16 v[32:47], v[48:51], v[108:111], 0
    v_exp_f32 v21, v21
    v_exp_f32 v22, v22
    v_exp_f32 v23, v23
    v_exp_f32 v24, v24
    v_exp_f32 v25, v25
    v_exp_f32 v26, v26
    v_exp_f32 v27, v27
    v_exp_f32 v28, v28
    v_exp_f32 v29, v29
    v_exp_f32 v30, v30
    v_smfmac_f32_32x32x32_bf16 v[176:191], v[88:91], v[16:23], v1
    v_exp_f32 v31, v31
    v_exp_f32 v32, v32
    v_exp_f32 v33, v33
    v_smfmac_f32_32x32x32_bf16 v[176:191], v[92:95], v[24:31], v1
    v_exp_f32 v34, v34
    v_exp_f32 v35, v35
    v_exp_f32 v36, v36
    v_mfma_f32_32x32x16_bf16 v[16:31], v[60:63], v[108:111], 0
    v_exp_f32 v37, v37
    v_exp_f32 v38, v38
    v_exp_f32 v39, v39
    v_exp_f32 v40, v40
    v_exp_f32 v41, v41
    v_exp_f32 v42, v42
    v_exp_f32 v43, v43
    v_exp_f32 v44, v44
    v_exp_f32 v45, v45
    v_exp_f32 v46, v46
    v_smfmac_f32_32x32x32_bf16 v[176:191], v[52:55], v[32:39], v1
    v_exp_f32 v47, v47
    v_exp_f32 v16, v16
    v_exp_f32 v17, v17
    v_smfmac_f32_32x32x32_bf16 v[176:191], v[56:59], v[40:47], v1
    v_exp_f32 v18, v18
    v_exp_f32 v19, v19
    v_exp_f32 v20, v20
    v_mfma_f32_32x32x16_bf16 v[32:47], v[72:75], v[112:115], 0
    v_exp_f32 v21, v21
    v_exp_f32 v22, v22
    ds_read_b32 v136, v9 offset:24832
    ds_read_b32 v154, v10 offset:25856
    ds_read_b32 v168, v11 offset:26880
    ds_read_b128 v[128:131], v6 offset:0
    ds_read_b128 v[132:135], v6 offset:1024
    ds_read_b128 v[146:149], v7 offset:8192
    ds_read_b128 v[150:153], v7 offset:9216
    ds_read_b128 v[160:163], v8 offset:16384
    ds_read_b128 v[164:167], v8 offset:17408
    v_exp_f32 v23, v23
    v_exp_f32 v24, v24
    v_exp_f32 v25, v25
    v_exp_f32 v26, v26
    v_exp_f32 v27, v27
    v_exp_f32 v28, v28
    v_exp_f32 v29, v29
    v_exp_f32 v30, v30
    v_smfmac_f32_32x32x32_bf16 v[176:191], v[64:67], v[16:23], v1
    v_exp_f32 v31, v31
    v_exp_f32 v32, v32
    v_exp_f32 v33, v33
    v_smfmac_f32_32x32x32_bf16 v[176:191], v[68:71], v[24:31], v1
    v_exp_f32 v34, v34
    v_exp_f32 v35, v35
    v_exp_f32 v36, v36
    v_mfma_f32_32x32x16_bf16 v[16:31], v[84:87], v[112:115], 0
    v_exp_f32 v37, v37
    v_exp_f32 v38, v38
    v_exp_f32 v39, v39
    v_exp_f32 v40, v40
    v_exp_f32 v41, v41
    v_exp_f32 v42, v42
    v_exp_f32 v43, v43
    v_exp_f32 v44, v44
    s_waitcnt lgkmcnt(0)
    v_add_f32 v139, v136, v154
    v_pk_add_f32 v[146:147], v[146:147], v[128:129]
    v_pk_add_f32 v[148:149], v[148:149], v[130:131]
    v_pk_add_f32 v[150:151], v[150:151], v[132:133]
    v_pk_add_f32 v[152:153], v[152:153], v[134:135]
    v_add_f32 v139, v139, v168
    v_pk_add_f32 v[146:147], v[146:147], v[160:161]
    v_pk_add_f32 v[148:149], v[148:149], v[162:163]
    v_pk_add_f32 v[150:151], v[150:151], v[164:165]
    v_pk_add_f32 v[152:153], v[152:153], v[166:167]
    v_add_f32 v139, v139, v184
    v_pk_add_f32 v[146:147], v[146:147], v[176:177]
    v_rcp_f32 v140, v139
    v_subrev_u32 v138, 0x2b800000, v139
    v_pk_add_f32 v[148:149], v[148:149], v[178:179]
    v_cmp_le_u32 vcc, 0x32000000, v138
    v_pk_add_f32 v[150:151], v[150:151], v[180:181]
    v_pk_add_f32 v[152:153], v[152:153], v[182:183]
    v_mul_f32 v140, v140, v3
    v_pk_mul_f32 v[146:147], v[146:147], v[140:141] op_sel_hi:[1,0]
    v_pk_mul_f32 v[148:149], v[148:149], v[140:141] op_sel_hi:[1,0]
    v_pk_mul_f32 v[150:151], v[150:151], v[140:141] op_sel_hi:[1,0]
    v_pk_mul_f32 v[152:153], v[152:153], v[140:141] op_sel_hi:[1,0]
    v_cvt_pk_bf16_f32 v146, v146, v147
    v_cvt_pk_bf16_f32 v147, v148, v149
    v_cvt_pk_bf16_f32 v148, v150, v151
    v_cvt_pk_bf16_f32 v149, v152, v153
    v_min_u32 v146, -2, v146
    s_cbranch_vccnz L_retry0
L_back0:
    buffer_store_dwordx4 v[146:149], v4, s[44:47], s81 offen offset:0 sc1
L_near0:
    v_exp_f32 v45, v45
    v_exp_f32 v46, v46
    v_smfmac_f32_32x32x32_bf16 v[192:207], v[76:79], v[32:39], v1
    v_exp_f32 v47, v47
    v_exp_f32 v16, v16
    v_exp_f32 v17, v17
    v_smfmac_f32_32x32x32_bf16 v[192:207], v[80:83], v[40:47], v1
    v_exp_f32 v18, v18
    v_exp_f32 v19, v19
    v_exp_f32 v20, v20
    v_mfma_f32_32x32x16_bf16 v[32:47], v[48:51], v[112:115], 0
    v_exp_f32 v21, v21
    v_exp_f32 v22, v22
    v_exp_f32 v23, v23
    v_exp_f32 v24, v24
    v_exp_f32 v25, v25
    v_exp_f32 v26, v26
    v_exp_f32 v27, v27
    v_exp_f32 v28, v28
    v_exp_f32 v29, v29
    v_exp_f32 v30, v30
    v_smfmac_f32_32x32x32_bf16 v[192:207], v[88:91], v[16:23], v1
    v_exp_f32 v31, v31
    v_exp_f32 v32, v32
    v_exp_f32 v33, v33
    v_smfmac_f32_32x32x32_bf16 v[192:207], v[92:95], v[24:31], v1
    v_exp_f32 v34, v34
    v_exp_f32 v35, v35
    v_exp_f32 v36, v36
    v_mfma_f32_32x32x16_bf16 v[16:31], v[60:63], v[112:115], 0
    v_exp_f32 v37, v37
    v_exp_f32 v38, v38
    v_exp_f32 v39, v39
    v_exp_f32 v40, v40
    v_exp_f32 v41, v41
    v_exp_f32 v42, v42
    v_exp_f32 v43, v43
    v_exp_f32 v44, v44
    v_exp_f32 v45, v45
    v_exp_f32 v46, v46
    v_smfmac_f32_32x32x32_bf16 v[192:207], v[52:55], v[32:39], v1
    v_exp_f32 v47, v47
    v_exp_f32 v16, v16
    v_exp_f32 v17, v17
    v_smfmac_f32_32x32x32_bf16 v[192:207], v[56:59], v[40:47], v1
    v_exp_f32 v18, v18
    v_exp_f32 v19, v19
    v_exp_f32 v20, v20
    v_mfma_f32_32x32x16_bf16 v[32:47], v[72:75], v[116:119], 0
    v_exp_f32 v21, v21
    v_exp_f32 v22, v22
    v_exp_f32 v23, v23
    v_exp_f32 v24, v24
    v_exp_f32 v25, v25
    v_exp_f32 v26, v26
    v_exp_f32 v27, v27
    v_exp_f32 v28, v28
    v_exp_f32 v29, v29
    v_exp_f32 v30, v30
    v_smfmac_f32_32x32x32_bf16 v[192:207], v[64:67], v[16:23], v1
    v_exp_f32 v31, v31
    v_exp_f32 v32, v32
    v_exp_f32 v33, v33
    v_smfmac_f32_32x32x32_bf16 v[192:207], v[68:71], v[24:31], v1
    v_exp_f32 v34, v34
    v_exp_f32 v35, v35
    v_exp_f32 v36, v36
    v_mfma_f32_32x32x16_bf16 v[16:31], v[84:87], v[116:119], 0
    v_exp_f32 v37, v37
    v_exp_f32 v38, v38
    v_exp_f32 v39, v39
    v_exp_f32 v40, v40
    v_exp_f32 v41, v41
    v_exp_f32 v42, v42
    v_exp_f32 v43, v43
    v_exp_f32 v44, v44
    v_exp_f32 v45, v45
    ds_write_b128 v4, v[192:195] offset:32768
    ds_write_b128 v4, v[196:199] offset:33792
    ds_write_b32 v5, v200 offset:27904
    v_exp_f32 v46, v46
    v_smfmac_f32_32x32x32_bf16 v[208:223], v[76:79], v[32:39], v1
    v_exp_f32 v47, v47
    v_exp_f32 v16, v16
    v_exp_f32 v17, v17
    v_smfmac_f32_32x32x32_bf16 v[208:223], v[80:83], v[40:47], v1
    v_exp_f32 v18, v18
    v_exp_f32 v19, v19
    v_exp_f32 v20, v20
    v_mfma_f32_32x32x16_bf16 v[32:47], v[48:51], v[116:119], 0
    v_exp_f32 v21, v21
    v_exp_f32 v22, v22
    v_exp_f32 v23, v23
    v_exp_f32 v24, v24
    v_exp_f32 v25, v25
    v_exp_f32 v26, v26
    v_exp_f32 v27, v27
    v_exp_f32 v28, v28
    v_exp_f32 v29, v29
    v_exp_f32 v30, v30
    v_smfmac_f32_32x32x32_bf16 v[208:223], v[88:91], v[16:23], v1
    v_exp_f32 v31, v31
    v_exp_f32 v32, v32
    v_exp_f32 v33, v33
    v_smfmac_f32_32x32x32_bf16 v[208:223], v[92:95], v[24:31], v1
    v_exp_f32 v34, v34
    v_exp_f32 v35, v35
    v_exp_f32 v36, v36
    v_mfma_f32_32x32x16_bf16 v[16:31], v[60:63], v[116:119], 0
    v_exp_f32 v37, v37
    v_exp_f32 v38, v38
    v_exp_f32 v39, v39
    v_exp_f32 v40, v40
    v_exp_f32 v41, v41
    v_exp_f32 v42, v42
    v_exp_f32 v43, v43
    v_exp_f32 v44, v44
    v_exp_f32 v45, v45
    v_exp_f32 v46, v46
    v_smfmac_f32_32x32x32_bf16 v[208:223], v[52:55], v[32:39], v1
    v_exp_f32 v47, v47
    v_exp_f32 v16, v16
    v_exp_f32 v17, v17
    v_smfmac_f32_32x32x32_bf16 v[208:223], v[56:59], v[40:47], v1
    v_exp_f32 v18, v18
    v_exp_f32 v19, v19
    v_exp_f32 v20, v20
    v_mfma_f32_32x32x16_bf16 v[32:47], v[72:75], v[120:123], 0
    v_exp_f32 v21, v21
    v_exp_f32 v22, v22
    v_exp_f32 v23, v23
    v_exp_f32 v24, v24
    v_exp_f32 v25, v25
    v_exp_f32 v26, v26
    v_exp_f32 v27, v27
    v_exp_f32 v28, v28
    v_exp_f32 v29, v29
    v_exp_f32 v30, v30
    v_smfmac_f32_32x32x32_bf16 v[208:223], v[64:67], v[16:23], v1
    v_exp_f32 v31, v31
    v_exp_f32 v32, v32
    v_exp_f32 v33, v33
    v_smfmac_f32_32x32x32_bf16 v[208:223], v[68:71], v[24:31], v1
    v_exp_f32 v34, v34
    v_exp_f32 v35, v35
    v_exp_f32 v36, v36
    v_mfma_f32_32x32x16_bf16 v[16:31], v[84:87], v[120:123], 0
    v_exp_f32 v37, v37
    v_exp_f32 v38, v38
    v_exp_f32 v39, v39
    v_exp_f32 v40, v40
    v_exp_f32 v41, v41
    v_exp_f32 v42, v42
    v_exp_f32 v43, v43
    v_exp_f32 v44, v44
    v_exp_f32 v45, v45
    ds_write_b128 v4, v[208:211] offset:40960
    ds_write_b128 v4, v[212:215] offset:41984
    ds_write_b32 v5, v216 offset:28928
    v_exp_f32 v46, v46
    v_smfmac_f32_32x32x32_bf16 v[224:239], v[76:79], v[32:39], v1
    v_exp_f32 v47, v47
    v_exp_f32 v16, v16
    v_exp_f32 v17, v17
    v_smfmac_f32_32x32x32_bf16 v[224:239], v[80:83], v[40:47], v1
    v_exp_f32 v18, v18
    v_exp_f32 v19, v19
    v_exp_f32 v20, v20
    v_mfma_f32_32x32x16_bf16 v[32:47], v[48:51], v[120:123], 0
    v_exp_f32 v21, v21
    v_exp_f32 v22, v22
    v_exp_f32 v23, v23
    v_exp_f32 v24, v24
    v_exp_f32 v25, v25
    v_exp_f32 v26, v26
    v_exp_f32 v27, v27
    v_exp_f32 v28, v28
    v_exp_f32 v29, v29
    v_exp_f32 v30, v30
    v_smfmac_f32_32x32x32_bf16 v[224:239], v[88:91], v[16:23], v1
    v_exp_f32 v31, v31
    v_exp_f32 v32, v32
    v_exp_f32 v33, v33
    v_smfmac_f32_32x32x32_bf16 v[224:239], v[92:95], v[24:31], v1
    v_exp_f32 v34, v34
    v_exp_f32 v35, v35
    v_exp_f32 v36, v36
    v_mfma_f32_32x32x16_bf16 v[16:31], v[60:63], v[120:123], 0
    v_exp_f32 v37, v37
    v_exp_f32 v38, v38
    v_exp_f32 v39, v39
    v_exp_f32 v40, v40
    v_exp_f32 v41, v41
    v_exp_f32 v42, v42
    v_exp_f32 v43, v43
    v_exp_f32 v44, v44
    v_exp_f32 v45, v45
    v_exp_f32 v46, v46
    v_smfmac_f32_32x32x32_bf16 v[224:239], v[52:55], v[32:39], v1
    v_exp_f32 v47, v47
    v_exp_f32 v16, v16
    v_exp_f32 v17, v17
    v_smfmac_f32_32x32x32_bf16 v[224:239], v[56:59], v[40:47], v1
    v_exp_f32 v18, v18
    v_exp_f32 v19, v19
    v_exp_f32 v20, v20
    v_mfma_f32_32x32x16_bf16 v[32:47], v[72:75], v[124:127], 0
    v_exp_f32 v21, v21
    v_exp_f32 v22, v22
    v_exp_f32 v23, v23
    v_exp_f32 v24, v24
    v_exp_f32 v25, v25
    v_exp_f32 v26, v26
    v_exp_f32 v27, v27
    v_exp_f32 v28, v28
    v_exp_f32 v29, v29
    v_exp_f32 v30, v30
    v_smfmac_f32_32x32x32_bf16 v[224:239], v[64:67], v[16:23], v1
    v_exp_f32 v31, v31
    v_exp_f32 v32, v32
    v_exp_f32 v33, v33
    v_smfmac_f32_32x32x32_bf16 v[224:239], v[68:71], v[24:31], v1
    v_exp_f32 v34, v34
    v_exp_f32 v35, v35
    v_exp_f32 v36, v36
    v_mfma_f32_32x32x16_bf16 v[16:31], v[84:87], v[124:127], 0
    v_exp_f32 v37, v37
    v_exp_f32 v38, v38
    v_exp_f32 v39, v39
    v_exp_f32 v40, v40
    v_exp_f32 v41, v41
    v_exp_f32 v42, v42
    v_exp_f32 v43, v43
    v_exp_f32 v44, v44
    v_exp_f32 v45, v45
    ds_write_b128 v4, v[224:227] offset:49152
    ds_write_b128 v4, v[228:231] offset:50176
    ds_write_b32 v5, v232 offset:29952
    v_exp_f32 v46, v46
    v_smfmac_f32_32x32x32_bf16 v[240:255], v[76:79], v[32:39], v1
    v_exp_f32 v47, v47
    v_exp_f32 v16, v16
    v_exp_f32 v17, v17
    v_smfmac_f32_32x32x32_bf16 v[240:255], v[80:83], v[40:47], v1
    v_exp_f32 v18, v18
    v_exp_f32 v19, v19
    v_exp_f32 v20, v20
    v_mfma_f32_32x32x16_bf16 v[32:47], v[48:51], v[124:127], 0
    v_exp_f32 v21, v21
    v_exp_f32 v22, v22
    v_exp_f32 v23, v23
    v_exp_f32 v24, v24
    v_exp_f32 v25, v25
    v_exp_f32 v26, v26
    v_exp_f32 v27, v27
    v_exp_f32 v28, v28
    v_exp_f32 v29, v29
    v_exp_f32 v30, v30
    v_smfmac_f32_32x32x32_bf16 v[240:255], v[88:91], v[16:23], v1
    v_exp_f32 v31, v31
    v_exp_f32 v32, v32
    v_exp_f32 v33, v33
    v_smfmac_f32_32x32x32_bf16 v[240:255], v[92:95], v[24:31], v1
    v_exp_f32 v34, v34
    v_exp_f32 v35, v35
    v_exp_f32 v36, v36
    v_mfma_f32_32x32x16_bf16 v[16:31], v[60:63], v[124:127], 0
    v_exp_f32 v37, v37
    v_exp_f32 v38, v38
    v_exp_f32 v39, v39
    v_exp_f32 v40, v40
    v_exp_f32 v41, v41
    v_exp_f32 v42, v42
    v_exp_f32 v43, v43
    v_exp_f32 v44, v44
    v_exp_f32 v45, v45
    v_exp_f32 v46, v46
    v_smfmac_f32_32x32x32_bf16 v[240:255], v[52:55], v[32:39], v1
    v_exp_f32 v47, v47
    v_exp_f32 v16, v16
    v_exp_f32 v17, v17
    v_smfmac_f32_32x32x32_bf16 v[240:255], v[56:59], v[40:47], v1
    v_exp_f32 v18, v18
    v_exp_f32 v19, v19
    v_exp_f32 v20, v20
    v_exp_f32 v21, v21
    v_exp_f32 v22, v22
    ds_read_b32 v200, v9 offset:27904
    ds_read_b32 v218, v10 offset:28928
    ds_read_b32 v232, v11 offset:29952
    ds_read_b128 v[192:195], v6 offset:32768
    ds_read_b128 v[196:199], v6 offset:33792
    ds_read_b128 v[210:213], v7 offset:40960
    ds_read_b128 v[214:217], v7 offset:41984
    ds_read_b128 v[224:227], v8 offset:49152
    ds_read_b128 v[228:231], v8 offset:50176
    v_exp_f32 v23, v23
    v_exp_f32 v24, v24
    v_exp_f32 v25, v25
    v_smfmac_f32_32x32x32_bf16 v[240:255], v[64:67], v[16:23], v1
    v_exp_f32 v26, v26
    v_exp_f32 v27, v27
    v_exp_f32 v28, v28
    v_exp_f32 v29, v29
    v_exp_f32 v30, v30
    v_exp_f32 v31, v31
    s_nop 1
    v_smfmac_f32_32x32x32_bf16 v[240:255], v[68:71], v[24:31], v1
    s_waitcnt lgkmcnt(0)
    v_add_f32 v203, v200, v218
    v_pk_add_f32 v[210:211], v[210:211], v[192:193]
    v_pk_add_f32 v[212:213], v[212:213], v[194:195]
    v_pk_add_f32 v[214:215], v[214:215], v[196:197]
    v_pk_add_f32 v[216:217], v[216:217], v[198:199]
    v_add_f32 v203, v203, v232
    v_pk_add_f32 v[210:211], v[210:211], v[224:225]
    v_pk_add_f32 v[212:213], v[212:213], v[226:227]
    v_pk_add_f32 v[214:215], v[214:215], v[228:229]
    v_pk_add_f32 v[216:217], v[216:217], v[230:231]
    s_nop 0
    v_add_f32 v203, v203, v248
    v_pk_add_f32 v[210:211], v[210:211], v[240:241]
    v_rcp_f32 v204, v203
    v_subrev_u32 v202, 0x2b800000, v203
    v_pk_add_f32 v[212:213], v[212:213], v[242:243]
    v_cmp_le_u32 vcc, 0x32000000, v202
    v_pk_add_f32 v[214:215], v[214:215], v[244:245]
    v_pk_add_f32 v[216:217], v[216:217], v[246:247]
    v_mul_f32 v204, v204, v3
    v_pk_mul_f32 v[210:211], v[210:211], v[204:205] op_sel_hi:[1,0]
    v_pk_mul_f32 v[212:213], v[212:213], v[204:205] op_sel_hi:[1,0]
    v_pk_mul_f32 v[214:215], v[214:215], v[204:205] op_sel_hi:[1,0]
    v_pk_mul_f32 v[216:217], v[216:217], v[204:205] op_sel_hi:[1,0]
    v_cvt_pk_bf16_f32 v210, v210, v211
    v_cvt_pk_bf16_f32 v211, v212, v213
    v_cvt_pk_bf16_f32 v212, v214, v215
    v_cvt_pk_bf16_f32 v213, v216, v217
    v_min_u32 v210, -2, v210
    s_cbranch_vccnz L_retry1
L_back1:
    s_cmp_lg_u32 s38, 0
    s_cbranch_scc1 L_far1
    buffer_store_dwordx4 v[210:213], v4, s[44:47], s81 offen offset:1024
L_near1:
    s_barrier
    s_endpgm
L_retry0:
    s_mov_b32 s31, 200000
L_retryl0:
    ds_read_b32 v136, v9 offset:24832
    ds_read_b32 v154, v10 offset:25856
    ds_read_b32 v168, v11 offset:26880
    ds_read_b128 v[128:131], v6 offset:0
    ds_read_b128 v[132:135], v6 offset:1024
    ds_read_b128 v[146:149], v7 offset:8192
    ds_read_b128 v[150:153], v7 offset:9216
    ds_read_b128 v[160:163], v8 offset:16384
    ds_read_b128 v[164:167], v8 offset:17408
    s_waitcnt lgkmcnt(0)
    v_max3_u32 v138, v136, v154, v168
    v_cmp_eq_u32 vcc, -1, v138
    s_cbranch_vccz L_ok_1
    s_sub_u32 s31, s31, 1
    s_cmp_lg_u32 s31, 0
    s_cbranch_scc1 L_retryl0
L_ok_1:
    s_waitcnt lgkmcnt(0)
    v_add_f32 v139, v136, v154
    v_pk_add_f32 v[146:147], v[146:147], v[128:129]
    v_pk_add_f32 v[148:149], v[148:149], v[130:131]
    v_pk_add_f32 v[150:151], v[150:151], v[132:133]
    v_pk_add_f32 v[152:153], v[152:153], v[134:135]
    v_add_f32 v139, v139, v168
    v_pk_add_f32 v[146:147], v[146:147], v[160:161]
    v_pk_add_f32 v[148:149], v[148:149], v[162:163]
    v_pk_add_f32 v[150:151], v[150:151], v[164:165]
    v_pk_add_f32 v[152:153], v[152:153], v[166:167]
    v_add_f32 v139, v139, v184
    v_pk_add_f32 v[146:147], v[146:147], v[176:177]
    v_rcp_f32 v140, v139
    v_subrev_u32 v138, 0x2b800000, v139
    v_pk_add_f32 v[148:149], v[148:149], v[178:179]
    v_cmp_le_u32 vcc, 0x32000000, v138
    v_pk_add_f32 v[150:151], v[150:151], v[180:181]
    v_pk_add_f32 v[152:153], v[152:153], v[182:183]
    v_mul_f32 v140, v140, v3
    v_pk_mul_f32 v[146:147], v[146:147], v[140:141] op_sel_hi:[1,0]
    v_pk_mul_f32 v[148:149], v[148:149], v[140:141] op_sel_hi:[1,0]
    v_pk_mul_f32 v[150:151], v[150:151], v[140:141] op_sel_hi:[1,0]
    v_pk_mul_f32 v[152:153], v[152:153], v[140:141] op_sel_hi:[1,0]
    v_cvt_pk_bf16_f32 v146, v146, v147
    v_cvt_pk_bf16_f32 v147, v148, v149
    v_cvt_pk_bf16_f32 v148, v150, v151
    v_cvt_pk_bf16_f32 v149, v152, v153
    v_min_u32 v146, -2, v146
    s_cbranch_vccnz L_slow0
    s_branch L_back0
L_slowed0:
    v_rcp_f32 v140, v184
    s_nop 0
    v_mul_f32 v140, v140, v3
    v_pk_mul_f32 v[146:147], v[176:177], v[140:141] op_sel_hi:[1,0]
    v_pk_mul_f32 v[148:149], v[178:179], v[140:141] op_sel_hi:[1,0]
    v_pk_mul_f32 v[150:151], v[180:181], v[140:141] op_sel_hi:[1,0]
    v_pk_mul_f32 v[152:153], v[182:183], v[140:141] op_sel_hi:[1,0]
    v_cvt_pk_bf16_f32 v146, v146, v147
    v_cvt_pk_bf16_f32 v147, v148, v149
    v_cvt_pk_bf16_f32 v148, v150, v151
    v_cvt_pk_bf16_f32 v149, v152, v153
    v_min_u32 v146, -2, v146
    s_branch L_back0
L_far0:
    buffer_store_dwordx4 v[146:149], v4, s[44:47], s81 offen offset:0 sc1
    s_branch L_near0
L_retry1:
    s_mov_b32 s31, 200000
L_retryl1:
    ds_read_b32 v200, v9 offset:27904
    ds_read_b32 v218, v10 offset:28928
    ds_read_b32 v232, v11 offset:29952
    ds_read_b128 v[192:195], v6 offset:32768
    ds_read_b128 v[196:199], v6 offset:33792
    ds_read_b128 v[210:213], v7 offset:40960
    ds_read_b128 v[214:217], v7 offset:41984
    ds_read_b128 v[224:227], v8 offset:49152
    ds_read_b128 v[228:231], v8 offset:50176
    s_waitcnt lgkmcnt(0)
    v_max3_u32 v202, v200, v218, v232
    v_cmp_eq_u32 vcc, -1, v202
    s_cbranch_vccz L_ok_2
    s_sub_u32 s31, s31, 1
    s_cmp_lg_u32 s31, 0
    s_cbranch_scc1 L_retryl1
L_ok_2:
    s_waitcnt lgkmcnt(0)
    v_add_f32 v203, v200, v218
    v_pk_add_f32 v[210:211], v[210:211], v[192:193]
    v_pk_add_f32 v[212:213], v[212:213], v[194:195]
    v_pk_add_f32 v[214:215], v[214:215], v[196:197]
    v_pk_add_f32 v[216:217], v[216:217], v[198:199]
    v_add_f32 v203, v203, v232
    v_pk_add_f32 v[210:211], v[210:211], v[224:225]
    v_pk_add_f32 v[212:213], v[212:213], v[226:227]
    v_pk_add_f32 v[214:215], v[214:215], v[228:229]
    v_pk_add_f32 v[216:217], v[216:217], v[230:231]
    v_add_f32 v203, v203, v248
    v_pk_add_f32 v[210:211], v[210:211], v[240:241]
    v_rcp_f32 v204, v203
    v_subrev_u32 v202, 0x2b800000, v203
    v_pk_add_f32 v[212:213], v[212:213], v[242:243]
    v_cmp_le_u32 vcc, 0x32000000, v202
    v_pk_add_f32 v[214:215], v[214:215], v[244:245]
    v_pk_add_f32 v[216:217], v[216:217], v[246:247]
    v_mul_f32 v204, v204, v3
    v_pk_mul_f32 v[210:211], v[210:211], v[204:205] op_sel_hi:[1,0]
    v_pk_mul_f32 v[212:213], v[212:213], v[204:205] op_sel_hi:[1,0]
    v_pk_mul_f32 v[214:215], v[214:215], v[204:205] op_sel_hi:[1,0]
    v_pk_mul_f32 v[216:217], v[216:217], v[204:205] op_sel_hi:[1,0]
    v_cvt_pk_bf16_f32 v210, v210, v211
    v_cvt_pk_bf16_f32 v211, v212, v213
    v_cvt_pk_bf16_f32 v212, v214, v215
    v_cvt_pk_bf16_f32 v213, v216, v217
    v_min_u32 v210, -2, v210
    s_cbranch_vccnz L_slow1
    s_branch L_back1
L_slowed1:
    v_rcp_f32 v204, v248
    s_nop 0
    v_mul_f32 v204, v204, v3
    v_pk_mul_f32 v[210:211], v[240:241], v[204:205] op_sel_hi:[1,0]
    v_pk_mul_f32 v[212:213], v[242:243], v[204:205] op_sel_hi:[1,0]
    v_pk_mul_f32 v[214:215], v[244:245], v[204:205] op_sel_hi:[1,0]
    v_pk_mul_f32 v[216:217], v[246:247], v[204:205] op_sel_hi:[1,0]
    v_cvt_pk_bf16_f32 v210, v210, v211
    v_cvt_pk_bf16_f32 v211, v212, v213
    v_cvt_pk_bf16_f32 v212, v214, v215
    v_cvt_pk_bf16_f32 v213, v216, v217
    v_min_u32 v210, -2, v210
    s_branch L_back1
L_far1:
    buffer_store_dwordx4 v[210:213], v4, s[44:47], s81 offen offset:1024 sc1
    s_branch L_near1
L_tf0:
    s_mov_b32 s31, 200000
L_tfl0:
    buffer_load_dword v61, v13, s[44:47], s80 offen sc1
    s_waitcnt vmcnt(0)
    v_cmp_ne_u32 vcc, s30, v61
    s_and_b64 vcc, vcc, 0xff
    s_cbranch_vccz L_ok_3
    s_sub_u32 s31, s31, 1
    s_cmp_lg_u32 s31, 0
    s_cbranch_scc1 L_tfl0
L_ok_3:
    buffer_load_dwordx4 v[48:51], v2, s[44:47], s60 offen offset:0 sc1
    buffer_load_dwordx4 v[56:59], v3, s[44:47], s60 offen offset:1024 sc1
    buffer_load_dwordx4 v[64:67], v3, s[44:47], s60 offen offset:1536 sc1
    s_waitcnt vmcnt(0)
    s_branch L_tg0
L_tf1:
    s_mov_b32 s31, 200000
L_tfl1:
    buffer_load_dword v85, v13, s[44:47], s80 offen sc1
    s_waitcnt vmcnt(0)
    v_cmp_ne_u32 vcc, s30, v85
    s_and_b64 vcc, vcc, 0xff
    s_cbranch_vccz L_ok_4
    s_sub_u32 s31, s31, 1
    s_cmp_lg_u32 s31, 0
    s_cbranch_scc1 L_tfl1
L_ok_4:
    buffer_load_dwordx4 v[72:75], v2, s[44:47], s60 offen offset:2048 sc1
    buffer_load_dwordx4 v[80:83], v3, s[44:47], s60 offen offset:3072 sc1
    buffer_load_dwordx4 v[88:91], v3, s[44:47], s60 offen offset:3584 sc1
    s_waitcnt vmcnt(0)
    s_branch L_tg1
L_qretry:
    s_mov_b32 s31, 200000
L_qretryl:
    ds_read_b32 v63, v14 offset:32256
    ds_read_b128 v[96:99], v60 offset:0
    ds_read_b128 v[100:103], v61 offset:0
    ds_read_b128 v[104:107], v62 offset:0
    ds_read_b128 v[112:115], v60 offset:1024
    ds_read_b128 v[116:119], v61 offset:1024
    ds_read_b128 v[120:123], v62 offset:1024
    s_waitcnt lgkmcnt(0)
    v_cmp_gt_i32 vcc, 1, v63
    s_cbranch_vccz L_ok_5
    s_sub_u32 s31, s31, 1
    s_cmp_lg_u32 s31, 0
    s_cbranch_scc1 L_qretryl
L_ok_5:
    s_branch L_qgot
L_fretry:
    s_mov_b32 s31, 200000
L_fretryl:
    buffer_load_dword v60, v13, s[44:47], s90 offen sc1
    buffer_load_dwordx2 v[62:63], v13, s[44:47], s91 offen sc1
    s_waitcnt vmcnt(0)
    v_cmp_ne_u32 vcc, s30, v60
    s_cbranch_vccz L_ok_6
    s_sub_u32 s31, s31, 1
    s_cmp_lg_u32 s31, 0
    s_cbranch_scc1 L_fretryl
L_ok_6:
    s_branch L_fgot
L_bretry:
    s_mov_b32 s31, 200000
L_bretryl:
    ds_read_b32 v2, v14 offset:32512
    ds_read_b32 v3, v12 offset:32000
    s_waitcnt lgkmcnt(0)
    v_cmp_gt_i32 vcc, 2, v2
    s_cbranch_vccz L_ok_7
    s_sleep 1
    s_sub_u32 s31, s31, 1
    s_cmp_lg_u32 s31, 0
    s_cbranch_scc1 L_bretryl
L_ok_7:
    s_branch L_bgot
L_B:
    v_lshlrev_b32 v10, 4, v0
    v_lshlrev_b32 v11, 2, v0
    s_mov_b64 s[52:53], s[22:23]
    s_mov_b32 s54, 1024
    s_mov_b32 s55, 0x20000
    v_and_b32 v16, 15, v0
    v_and_b32 v17, 48, v0
    v_lshl_or_b32 v16, v16, 6, v17
    s_lshr_b32 s75, s86, 9
    v_xor_b32 v16, s75, v16
    buffer_load_dwordx4 v[100:103], v16, s[52:55], 0 offen
    s_lshl2_add_u32 s94, s2, s71
    v_and_b32 v16, 15, v0
    v_lshrrev_b32 v226, 1, v16
    v_lshrrev_b32 v17, 4, v0
    v_xor_b32 v226, v226, v17
    v_lshlrev_b32 v226, 4, v226
    v_lshl_add_u32 v226, v16, 7, v226
    s_lshl_b32 s73, s71, 11
    s_add_u32 s73, s73, 32768
    v_add_u32 v226, s73, v226
    v_xor_b32 v227, 64, v226
    s_lshl_b32 s73, s71, 6
    v_lshl_add_u32 v229, v16, 2, s73
    v_mov_b32 v17, 0
    ds_write2st64_b32 v229, v17, v17 offset0:126 offset1:127
    s_lshl_b32 s76, s68, 7
    s_lshl3_add_u32 s76, s69, s76
    s_add_u32 s76, s76, 4096
    s_cmp_eq_u32 s71, 3
    s_cselect_b32 s66, 11534336, 0
    s_mov_b64 s[64:65], s[28:29]
    s_mov_b32 s67, 0x20000
    s_getreg_b32 s73, hwreg(HW_REG_XCC_ID, 0, 4)
    v_mov_b32 v231, s73
    s_lshl_b32 s80, s71, 14
    s_add_u32 s80, s80, 98304
    s_lshl2_add_u32 s83, s69, s71
    s_xor_b32 s83, s83, 16
    s_cmp_gt_u32 s83, 28
    s_cselect_b32 s38, 0, 1409024
    s_mov_b32 s39, 0x20000
    s_mov_b64 s[36:37], s[16:17]
    s_mov_b64 s[40:41], s[18:19]
    s_mov_b64 s[42:43], s[38:39]
    s_mul_i32 s73, s83, 96
    v_add_u32 v16, s73, v10
    v_mul_u32_u24 v17, 10923, v0
    s_movk_i32 s73, 2656
    v_lshrrev_b32 v18, 16, v17
    v_mad_u32_u24 v208, v18, s73, v16
    v_add_u32 v17, 699072, v17
    v_lshrrev_b32 v18, 16, v17
    v_mad_u32_u24 v209, v18, s73, v16
    v_add_u32 v17, 699072, v17
    v_lshrrev_b32 v18, 16, v17
    v_mad_u32_u24 v210, v18, s73, v16
    s_bfe_u32 s74, s68, 0x10003
    s_lshl1_add_u32 s70, s70, s74
    s_mul_i32 s81, s70, 88064
    s_mul_i32 s78, s71, 3072
    v_and_b32 v16, 0x2c, v0
    v_mul_u32_u24 v16, 24, v16
    v_and_b32 v17, 3, v0
    v_lshl_add_u32 v16, v17, 3, v16
    v_and_b32 v17, 16, v0
    v_mul_u32_u24 v18, 200, v17
    v_mul_u32_u24 v17, 776, v17
    v_add3_u32 v214, v16, v18, s80
    v_add3_u32 v215, v16, v17, s78
    s_lshl_b32 s74, s74, 6
    s_add_u32 s74, s74, 32768
    v_and_b32 v220, 31, v0
    v_bfe_u32 v16, v0, 1, 3
    v_lshrrev_b32 v17, 5, v0
    v_xor_b32 v16, v16, v17
    v_lshlrev_b32 v16, 4, v16
    v_lshl_add_u32 v220, v220, 7, v16
    v_xor_b32 v220, s74, v220
    v_xor_b32 v221, 32, v220
    v_xor_b32 v222, 64, v220
    v_xor_b32 v223, 96, v220
    v_and_b32 v16, 3, v0
    v_mul_u32_u24 v16, 20, v16
    v_and_b32 v17, 24, v0
    v_mul_u32_u24 v17, 10, v17
    v_and_b32 v17, 96, v17
    v_and_or_b32 v16, v16, 24, v17
    v_and_b32 v17, 12, v0
    v_lshl_or_b32 v16, v17, 5, v16
    v_and_b32 v17, 32, v0
    v_lshl_or_b32 v16, v17, 4, v16
    s_lshr_b32 s73, s71, 1
    s_mul_i32 s73, s73, 2112
    s_add_u32 s73, s73, 57344
    v_xor_b32 v6, s73, v16
    v_xor_b32 v7, 64, v6
    v_add_u32 v8, 0x10000, v6
    v_add_u32 v9, 0x10000, v7
    v_and_b32 v16, 31, v0
    s_lshl_b32 s73, s68, 10
    s_add_u32 s95, s73, 8192
    v_lshl_add_u32 v232, v16, 5, s95
    s_lshl_b32 s73, s68, 8
    s_add_u32 s73, s73, 40960
    v_lshl_add_u32 v216, v16, 2, s73
    s_lshl2_add_u32 s82, s83, s73
    s_movk_i32 s73, 30976
    v_lshl_add_u32 v13, v16, 2, s73
    s_and_b32 s73, s71, 2
    s_lshl_b32 s73, s73, 6
    v_lshl_add_u32 v2, v16, 2, s73
    v_mov_b32 v240, 0x20001
    v_mov_b32 v241, 0x40003
    v_mov_b32 v242, 0x60005
    v_mov_b32 v243, 0x80007
    v_mov_b32 v244, 0xa0009
    v_mov_b32 v245, 0xc000b
    v_mov_b32 v252, v37
    v_add_u32 v253, 98304, v37
    v_add_u32 v254, 196608, v37
    v_add_u32 v255, 294912, v37
    s_cmp_eq_u32 s71, 3
    s_cbranch_scc1 L_Bp
    s_waitcnt vmcnt(1)
    s_barrier
    s_waitcnt vmcnt(0) lgkmcnt(0)
    s_mul_i32 s30, s30, 0x9E3779B1
    s_add_u32 s30, s30, 0x7F4A7C15
    s_add_u32 m0, s92, 106496
    s_xor_b32 s89, s86, 262144
    buffer_load_dwordx4 v37, s[56:59], s89 offen lds
    s_add_u32 m0, s92, 110592
    s_xor_b32 s89, s86, 294912
    buffer_load_dwordx4 v37, s[56:59], s89 offen lds
    s_barrier
    s_branch L_B1
L_Bp:
    v_and_b32 v48, 48, v0
    v_and_b32 v54, 31, v0
    v_lshlrev_b32 v54, 3, v54
    v_lshl_add_u32 v48, v48, 4, v54
    v_xor_b32 v49, 128, v48
    v_and_b32 v54, 15, v0
    v_lshrrev_b32 v50, 1, v54
    v_lshrrev_b32 v55, 4, v0
    v_xor_b32 v50, v50, v55
    v_lshlrev_b32 v50, 4, v50
    v_lshl_add_u32 v50, v54, 7, v50
    s_lshl_b32 s73, s79, 11
    s_add_u32 s73, s73, 32768
    v_add_u32 v50, s73, v50
    v_xor_b32 v51, 64, v50
    s_mov_b32 s96, 0xffff
    s_mov_b32 s97, 0xffff
    s_cmp_lt_u32 s69, 4
    s_cbranch_scc1 L_BpV
    v_lshrrev_b32 v52, 5, v0
    v_lshlrev_b32 v52, 9, v52
    v_lshl_add_u32 v52, v54, 4, v52
    v_and_b32 v55, 1, v55
    v_lshl_add_u32 v53, v55, 10, v52
    s_lshr_b32 s73, s79, 1
    s_lshl1_add_u32 s91, s68, s73
    s_lshl_b32 s91, s91, 11
    s_and_b32 s73, s79, 1
    s_lshl_b32 s74, s73, 8
    s_lshl1_add_u32 s90, s91, s74
    s_add_u32 s90, s90, 196608
    s_lshl_b32 s73, s73, 8
    s_add_u32 s91, s91, s73
    s_add_u32 s93, s91, 458752
    s_add_u32 s91, s91, 65536
    s_mov_b32 s98, 0x3eb8aa3b
    s_mov_b32 s99, s98
    v_mov_b32 v92, 0x3f803f80
    v_mov_b32 v93, 0x3f803f80
    v_mov_b64 v[94:95], v[92:93]
    s_setprio 2
    s_waitcnt vmcnt(1)
    s_barrier
    ds_read_b128 v[112:115], v50 offset:0
    ds_read_b64_tr_b16 v[116:117], v48 offset:0
    ds_read_b64_tr_b16 v[118:119], v49 offset:0
    ds_read_b128 v[120:123], v51 offset:0
    ds_read_b64_tr_b16 v[124:125], v48 offset:1024
    ds_read_b64_tr_b16 v[126:127], v49 offset:1024
    ds_read_b128 v[128:131], v50 offset:8192
    ds_read_b64_tr_b16 v[132:133], v48 offset:2048
    ds_read_b64_tr_b16 v[134:135], v49 offset:2048
    ds_read_b128 v[136:139], v51 offset:8192
    ds_read_b64_tr_b16 v[140:141], v48 offset:3072
    ds_read_b64_tr_b16 v[142:143], v49 offset:3072
    ds_read_b128 v[144:147], v50 offset:16384
    ds_read_b64_tr_b16 v[148:149], v48 offset:4096
    ds_read_b64_tr_b16 v[150:151], v49 offset:4096
    ds_read_b128 v[152:155], v51 offset:16384
    ds_read_b64_tr_b16 v[156:157], v48 offset:5120
    ds_read_b64_tr_b16 v[158:159], v49 offset:5120
    s_waitcnt lgkmcnt(12)
    v_mfma_f32_16x16x32_bf16 v[76:79], v[116:119], v[112:115], 0
    v_mfma_f32_16x16x32_bf16 v[76:79], v[124:127], v[120:123], v[76:79]
    ds_read_b128 v[112:115], v50 offset:24576
    ds_read_b64_tr_b16 v[116:117], v48 offset:6144
    ds_read_b64_tr_b16 v[118:119], v49 offset:6144
    ds_read_b128 v[120:123], v51 offset:24576
    ds_read_b64_tr_b16 v[124:125], v48 offset:7168
    ds_read_b64_tr_b16 v[126:127], v49 offset:7168
    s_waitcnt lgkmcnt(12)
    v_mfma_f32_16x16x32_bf16 v[76:79], v[132:135], v[128:131], v[76:79]
    v_mfma_f32_16x16x32_bf16 v[76:79], v[140:143], v[136:139], v[76:79]
    ds_read_b128 v[128:131], v50 offset:32768
    ds_read_b64_tr_b16 v[132:133], v48 offset:8192
    ds_read_b64_tr_b16 v[134:135], v49 offset:8192
    ds_read_b128 v[136:139], v51 offset:32768
    ds_read_b64_tr_b16 v[140:141], v48 offset:9216
    ds_read_b64_tr_b16 v[142:143], v49 offset:9216
    s_waitcnt lgkmcnt(12)
    v_mfma_f32_16x16x32_bf16 v[76:79], v[148:151], v[144:147], v[76:79]
    v_mfma_f32_16x16x32_bf16 v[76:79], v[156:159], v[152:155], v[76:79]
    ds_read_b128 v[144:147], v50 offset:40960
    ds_read_b64_tr_b16 v[148:149], v48 offset:10240
    ds_read_b64_tr_b16 v[150:151], v49 offset:10240
    ds_read_b128 v[152:155], v51 offset:40960
    ds_read_b64_tr_b16 v[156:157], v48 offset:11264
    ds_read_b64_tr_b16 v[158:159], v49 offset:11264
    s_waitcnt lgkmcnt(12)
    v_mfma_f32_16x16x32_bf16 v[76:79], v[116:119], v[112:115], v[76:79]
    v_mfma_f32_16x16x32_bf16 v[76:79], v[124:127], v[120:123], v[76:79]
    ds_read_b128 v[112:115], v50 offset:49152
    ds_read_b64_tr_b16 v[116:117], v48 offset:12288
    ds_read_b64_tr_b16 v[118:119], v49 offset:12288
    ds_read_b128 v[120:123], v51 offset:49152
    ds_read_b64_tr_b16 v[124:125], v48 offset:13312
    ds_read_b64_tr_b16 v[126:127], v49 offset:13312
    s_waitcnt lgkmcnt(12)
    v_mfma_f32_16x16x32_bf16 v[76:79], v[132:135], v[128:131], v[76:79]
    v_mfma_f32_16x16x32_bf16 v[76:79], v[140:143], v[136:139], v[76:79]
    ds_read_b128 v[128:131], v50 offset:57344
    ds_read_b64_tr_b16 v[132:133], v48 offset:14336
    ds_read_b64_tr_b16 v[134:135], v49 offset:14336
    ds_read_b128 v[136:139], v51 offset:57344
    ds_read_b64_tr_b16 v[140:141], v48 offset:15360
    ds_read_b64_tr_b16 v[142:143], v49 offset:15360
    s_waitcnt lgkmcnt(12)
    v_mfma_f32_16x16x32_bf16 v[76:79], v[148:151], v[144:147], v[76:79]
    v_mfma_f32_16x16x32_bf16 v[76:79], v[156:159], v[152:155], v[76:79]
    s_waitcnt lgkmcnt(6)
    v_mfma_f32_16x16x32_bf16 v[76:79], v[116:119], v[112:115], v[76:79]
    v_mfma_f32_16x16x32_bf16 v[76:79], v[124:127], v[120:123], v[76:79]
    s_waitcnt lgkmcnt(0)
    v_mfma_f32_16x16x32_bf16 v[76:79], v[132:135], v[128:131], v[76:79]
    v_mfma_f32_16x16x32_bf16 v[76:79], v[140:143], v[136:139], v[76:79]
    s_branch L_Bp2
L_BpV:
    v_lshrrev_b32 v52, 5, v0
    v_lshlrev_b32 v52, 8, v52
    v_lshl_add_u32 v52, v54, 4, v52
    v_and_b32 v55, 1, v55
    v_lshl_add_u32 v53, v55, 9, v52
    s_lshr_b32 s73, s79, 1
    s_lshl1_add_u32 s91, s68, s73
    s_lshl_b32 s91, s91, 11
    s_and_b32 s73, s79, 1
    s_lshl_b32 s74, s73, 10
    s_lshl1_add_u32 s90, s91, s74
    s_add_u32 s90, s90, 198656
    s_lshl_b32 s73, s73, 9
    s_add_u32 s91, s91, s73
    s_add_u32 s93, s91, 459776
    s_add_u32 s91, s91, 66560
    s_mov_b32 s98, 1.0
    s_mov_b32 s99, s98
    v_mov_b32 v92, 0x3f803f80
    v_mov_b32 v93, 0x3f803f80
    v_mov_b64 v[94:95], v[92:93]
    s_setprio 2
    s_waitcnt vmcnt(1)
    s_barrier
    ds_read_b128 v[112:115], v50 offset:0
    ds_read_b64_tr_b16 v[116:117], v48 offset:0
    ds_read_b64_tr_b16 v[118:119], v49 offset:0
    ds_read_b128 v[120:123], v51 offset:0
    ds_read_b64_tr_b16 v[124:125], v48 offset:1024
    ds_read_b64_tr_b16 v[126:127], v49 offset:1024
    ds_read_b128 v[128:131], v50 offset:8192
    ds_read_b64_tr_b16 v[132:133], v48 offset:2048
    ds_read_b64_tr_b16 v[134:135], v49 offset:2048
    ds_read_b128 v[136:139], v51 offset:8192
    ds_read_b64_tr_b16 v[140:141], v48 offset:3072
    ds_read_b64_tr_b16 v[142:143], v49 offset:3072
    ds_read_b128 v[144:147], v50 offset:16384
    ds_read_b64_tr_b16 v[148:149], v48 offset:4096
    ds_read_b64_tr_b16 v[150:151], v49 offset:4096
    ds_read_b128 v[152:155], v51 offset:16384
    ds_read_b64_tr_b16 v[156:157], v48 offset:5120
    ds_read_b64_tr_b16 v[158:159], v49 offset:5120
    s_waitcnt lgkmcnt(12)
    v_mfma_f32_16x16x32_bf16 v[76:79], v[112:115], v[116:119], 0
    v_mfma_f32_16x16x32_bf16 v[76:79], v[120:123], v[124:127], v[76:79]
    ds_read_b128 v[112:115], v50 offset:24576
    ds_read_b64_tr_b16 v[116:117], v48 offset:6144
    ds_read_b64_tr_b16 v[118:119], v49 offset:6144
    ds_read_b128 v[120:123], v51 offset:24576
    ds_read_b64_tr_b16 v[124:125], v48 offset:7168
    ds_read_b64_tr_b16 v[126:127], v49 offset:7168
    s_waitcnt lgkmcnt(12)
    v_mfma_f32_16x16x32_bf16 v[76:79], v[128:131], v[132:135], v[76:79]
    v_mfma_f32_16x16x32_bf16 v[76:79], v[136:139], v[140:143], v[76:79]
    ds_read_b128 v[128:131], v50 offset:32768
    ds_read_b64_tr_b16 v[132:133], v48 offset:8192
    ds_read_b64_tr_b16 v[134:135], v49 offset:8192
    ds_read_b128 v[136:139], v51 offset:32768
    ds_read_b64_tr_b16 v[140:141], v48 offset:9216
    ds_read_b64_tr_b16 v[142:143], v49 offset:9216
    s_waitcnt lgkmcnt(12)
    v_mfma_f32_16x16x32_bf16 v[76:79], v[144:147], v[148:151], v[76:79]
    v_mfma_f32_16x16x32_bf16 v[76:79], v[152:155], v[156:159], v[76:79]
    ds_read_b128 v[144:147], v50 offset:40960
    ds_read_b64_tr_b16 v[148:149], v48 offset:10240
    ds_read_b64_tr_b16 v[150:151], v49 offset:10240
    ds_read_b128 v[152:155], v51 offset:40960
    ds_read_b64_tr_b16 v[156:157], v48 offset:11264
    ds_read_b64_tr_b16 v[158:159], v49 offset:11264
    s_waitcnt lgkmcnt(12)
    v_mfma_f32_16x16x32_bf16 v[76:79], v[112:115], v[116:119], v[76:79]
    v_mfma_f32_16x16x32_bf16 v[76:79], v[120:123], v[124:127], v[76:79]
    ds_read_b128 v[112:115], v50 offset:49152
    ds_read_b64_tr_b16 v[116:117], v48 offset:12288
    ds_read_b64_tr_b16 v[118:119], v49 offset:12288
    ds_read_b128 v[120:123], v51 offset:49152
    ds_read_b64_tr_b16 v[124:125], v48 offset:13312
    ds_read_b64_tr_b16 v[126:127], v49 offset:13312
    s_waitcnt lgkmcnt(12)
    v_mfma_f32_16x16x32_bf16 v[76:79], v[128:131], v[132:135], v[76:79]
    v_mfma_f32_16x16x32_bf16 v[76:79], v[136:139], v[140:143], v[76:79]
    ds_read_b128 v[128:131], v50 offset:57344
    ds_read_b64_tr_b16 v[132:133], v48 offset:14336
    ds_read_b64_tr_b16 v[134:135], v49 offset:14336
    ds_read_b128 v[136:139], v51 offset:57344
    ds_read_b64_tr_b16 v[140:141], v48 offset:15360
    ds_read_b64_tr_b16 v[142:143], v49 offset:15360
    s_waitcnt lgkmcnt(12)
    v_mfma_f32_16x16x32_bf16 v[76:79], v[144:147], v[148:151], v[76:79]
    v_mfma_f32_16x16x32_bf16 v[76:79], v[152:155], v[156:159], v[76:79]
    s_waitcnt lgkmcnt(6)
    v_mfma_f32_16x16x32_bf16 v[76:79], v[112:115], v[116:119], v[76:79]
    v_mfma_f32_16x16x32_bf16 v[76:79], v[120:123], v[124:127], v[76:79]
    s_waitcnt lgkmcnt(0)
    v_mfma_f32_16x16x32_bf16 v[76:79], v[128:131], v[132:135], v[76:79]
    v_mfma_f32_16x16x32_bf16 v[76:79], v[136:139], v[140:143], v[76:79]
L_Bp2:
    s_mul_i32 s30, s30, 0x9E3779B1
    s_add_u32 s30, s30, 0x7F4A7C15
    v_mov_b32 v55, s30
    s_nop 4
    v_pk_mul_f32 v[76:77], v[76:77], s[98:99]
    v_pk_mul_f32 v[78:79], v[78:79], s[98:99]
    v_cvt_pk_bf16_f32 v84, v76, v77
    v_cvt_pk_bf16_f32 v85, v78, v79
    v_cndmask_b32 v68, v84, v55, s[96:97]
    v_cndmask_b32 v69, v85, v55, s[96:97]
    v_cndmask_b32 v70, v55, v84, s[96:97]
    v_cndmask_b32 v71, v55, v85, s[96:97]
    buffer_store_dwordx4 v[68:71], v53, s[44:47], s90 offen sc1
    v_mov_b64 v[86:87], v[84:85]
    s_nop 1
    v_permlane16_swap_b32 v84, v86
    v_permlane16_swap_b32 v85, v87
    s_mov_b64 exec, s[96:97]
    buffer_store_dwordx4 v[84:87], v52, s[44:47], s91 offen sc1
    s_mov_b64 exec, 1
    buffer_store_dwordx4 v[92:95], off, s[44:47], s93 sc1
    s_mov_b64 exec, -1
    s_barrier
    s_setprio 0
    s_add_u32 m0, s92, 106496
    s_xor_b32 s89, s86, 262144
    buffer_load_dwordx4 v37, s[56:59], s89 offen lds
    s_add_u32 m0, s92, 110592
    s_xor_b32 s89, s86, 294912
    buffer_load_dwordx4 v37, s[56:59], s89 offen lds
L_B1:
    s_add_u32 m0, s92, 122880
    s_xor_b32 s89, s86, 327680
    buffer_load_dwordx4 v37, s[56:59], s89 offen lds
    s_add_u32 m0, s92, 126976
    s_xor_b32 s89, s86, 360448
    buffer_load_dwordx4 v37, s[56:59], s89 offen lds
    s_xor_b32 m0, s84, 67584
    s_xor_b32 s87, s85, 512
    buffer_load_dwordx4 v45, s[32:35], s87 offen lds
    s_xor_b32 m0, s84, 69632
    s_nop 0
    buffer_load_dwordx4 v46, s[32:35], s87 offen lds
    s_xor_b32 m0, s84, 71680
    s_nop 0
    buffer_load_dwordx4 v47, s[32:35], s87 offen lds
    s_add_u32 m0, s92, 139264
    s_xor_b32 s89, s86, 393216
    buffer_load_dwordx4 v37, s[56:59], s89 offen lds
    v_mov_b32 v230, s30
    s_waitcnt vmcnt(11)
    v_mov_b64_dpp v[112:113], v[100:101] row_newbcast:0 row_mask:0xf bank_mask:0xf
    v_mov_b64_dpp v[114:115], v[102:103] row_newbcast:0 row_mask:0xf bank_mask:0xf
    v_mov_b64_dpp v[116:117], v[100:101] row_newbcast:1 row_mask:0xf bank_mask:0xf
    v_mov_b64_dpp v[118:119], v[102:103] row_newbcast:1 row_mask:0xf bank_mask:0xf
    v_mov_b64_dpp v[120:121], v[100:101] row_newbcast:2 row_mask:0xf bank_mask:0xf
    v_mov_b64_dpp v[122:123], v[102:103] row_newbcast:2 row_mask:0xf bank_mask:0xf
    v_mov_b64_dpp v[124:125], v[100:101] row_newbcast:3 row_mask:0xf bank_mask:0xf
    v_mov_b64_dpp v[126:127], v[102:103] row_newbcast:3 row_mask:0xf bank_mask:0xf
    v_mov_b64_dpp v[128:129], v[100:101] row_newbcast:4 row_mask:0xf bank_mask:0xf
    v_mov_b64_dpp v[130:131], v[102:103] row_newbcast:4 row_mask:0xf bank_mask:0xf
    v_mov_b64_dpp v[132:133], v[100:101] row_newbcast:5 row_mask:0xf bank_mask:0xf
    v_mov_b64_dpp v[134:135], v[102:103] row_newbcast:5 row_mask:0xf bank_mask:0xf
    v_mov_b64_dpp v[136:137], v[100:101] row_newbcast:6 row_mask:0xf bank_mask:0xf
    v_mov_b64_dpp v[138:139], v[102:103] row_newbcast:6 row_mask:0xf bank_mask:0xf
    v_mov_b64_dpp v[140:141], v[100:101] row_newbcast:7 row_mask:0xf bank_mask:0xf
    v_mov_b64_dpp v[142:143], v[102:103] row_newbcast:7 row_mask:0xf bank_mask:0xf
    v_mov_b64_dpp v[144:145], v[100:101] row_newbcast:8 row_mask:0xf bank_mask:0xf
    v_mov_b64_dpp v[146:147], v[102:103] row_newbcast:8 row_mask:0xf bank_mask:0xf
    v_mov_b64_dpp v[148:149], v[100:101] row_newbcast:9 row_mask:0xf bank_mask:0xf
    v_mov_b64_dpp v[150:151], v[102:103] row_newbcast:9 row_mask:0xf bank_mask:0xf
    v_mov_b64_dpp v[152:153], v[100:101] row_newbcast:10 row_mask:0xf bank_mask:0xf
    v_mov_b64_dpp v[154:155], v[102:103] row_newbcast:10 row_mask:0xf bank_mask:0xf
    v_mov_b64_dpp v[156:157], v[100:101] row_newbcast:11 row_mask:0xf bank_mask:0xf
    v_mov_b64_dpp v[158:159], v[102:103] row_newbcast:11 row_mask:0xf bank_mask:0xf
    v_mov_b64_dpp v[160:161], v[100:101] row_newbcast:12 row_mask:0xf bank_mask:0xf
    v_mov_b64_dpp v[162:163], v[102:103] row_newbcast:12 row_mask:0xf bank_mask:0xf
    v_mov_b64_dpp v[164:165], v[100:101] row_newbcast:13 row_mask:0xf bank_mask:0xf
    v_mov_b64_dpp v[166:167], v[102:103] row_newbcast:13 row_mask:0xf bank_mask:0xf
    v_mov_b64_dpp v[168:169], v[100:101] row_newbcast:14 row_mask:0xf bank_mask:0xf
    v_mov_b64_dpp v[170:171], v[102:103] row_newbcast:14 row_mask:0xf bank_mask:0xf
    v_mov_b64_dpp v[172:173], v[100:101] row_newbcast:15 row_mask:0xf bank_mask:0xf
    v_mov_b64_dpp v[174:175], v[102:103] row_newbcast:15 row_mask:0xf bank_mask:0xf
    ds_read_b128 v[176:179], v226 offset:0
    ds_read_b128 v[180:183], v227 offset:0
    ds_read_b128 v[184:187], v226 offset:8192
    ds_read_b128 v[188:191], v227 offset:8192
    s_waitcnt lgkmcnt(3)
    v_mfma_f32_16x16x32_bf16 v[204:207], v[112:115], v[176:179], 0
    s_waitcnt lgkmcnt(2)
    v_mfma_f32_16x16x32_bf16 v[204:207], v[116:119], v[180:183], v[204:207]
    s_waitcnt lgkmcnt(1)
    v_mfma_f32_16x16x32_bf16 v[204:207], v[120:123], v[184:187], v[204:207]
    s_waitcnt lgkmcnt(0)
    v_mfma_f32_16x16x32_bf16 v[204:207], v[124:127], v[188:191], v[204:207]
    s_barrier
    s_add_u32 m0, s92, 143360
    s_xor_b32 s89, s86, 425984
    buffer_load_dwordx4 v37, s[56:59], s89 offen lds
    s_add_u32 m0, s92, 155648
    s_xor_b32 s89, s86, 458752
    buffer_load_dwordx4 v37, s[56:59], s89 offen lds
    s_add_u32 m0, s92, 159744
    s_xor_b32 s89, s86, 491520
    buffer_load_dwordx4 v37, s[56:59], s89 offen lds
    s_xor_b32 m0, s84, 83968
    s_xor_b32 s87, s85, 768
    buffer_load_dwordx4 v45, s[32:35], s87 offen lds
    s_xor_b32 m0, s84, 86016
    s_nop 0
    buffer_load_dwordx4 v46, s[32:35], s87 offen lds
    s_xor_b32 m0, s84, 88064
    s_nop 0
    buffer_load_dwordx4 v47, s[32:35], s87 offen lds
    s_setprio 0
    ds_read_b128 v[192:195], v226 offset:16384
    ds_read_b128 v[196:199], v227 offset:16384
    ds_read_b128 v[176:179], v226 offset:24576
    ds_read_b128 v[180:183], v227 offset:24576
    s_waitcnt lgkmcnt(3)
    v_mfma_f32_16x16x32_bf16 v[204:207], v[128:131], v[192:195], v[204:207]
    s_waitcnt lgkmcnt(2)
    v_mfma_f32_16x16x32_bf16 v[204:207], v[132:135], v[196:199], v[204:207]
    s_waitcnt lgkmcnt(1)
    v_mfma_f32_16x16x32_bf16 v[204:207], v[136:139], v[176:179], v[204:207]
    s_waitcnt lgkmcnt(0)
    v_mfma_f32_16x16x32_bf16 v[204:207], v[140:143], v[180:183], v[204:207]
    s_waitcnt vmcnt(7)
    s_barrier
    s_mov_b64 exec, 1
    buffer_store_dwordx2 v[230:231], off, s[64:67], s76 sc1
    s_mov_b64 exec, -1
    ds_read_b128 v[184:187], v226 offset:32768
    ds_read_b128 v[188:191], v227 offset:32768
    ds_read_b128 v[192:195], v226 offset:40960
    ds_read_b128 v[196:199], v227 offset:40960
    s_waitcnt lgkmcnt(3)
    v_mfma_f32_16x16x32_bf16 v[204:207], v[144:147], v[184:187], v[204:207]
    s_waitcnt lgkmcnt(2)
    v_mfma_f32_16x16x32_bf16 v[204:207], v[148:151], v[188:191], v[204:207]
    s_waitcnt lgkmcnt(1)
    v_mfma_f32_16x16x32_bf16 v[204:207], v[152:155], v[192:195], v[204:207]
    s_waitcnt lgkmcnt(0)
    v_mfma_f32_16x16x32_bf16 v[204:207], v[156:159], v[196:199], v[204:207]
    s_waitcnt vmcnt(1)
    s_barrier
    s_add_u32 m0, s78, 0
    s_nop 0
    buffer_load_dwordx4 v208, s[36:39], s81 offen offset:0 lds
    buffer_load_dwordx4 v209, s[36:39], s81 offen offset:1024 lds
    buffer_load_dwordx4 v210, s[36:39], s81 offen offset:2048 lds
    s_add_u32 m0, s78, 12416
    s_nop 0
    buffer_load_dwordx4 v208, s[40:43], s81 offen offset:0 lds
    buffer_load_dwordx4 v209, s[40:43], s81 offen offset:1024 lds
    buffer_load_dwordx4 v210, s[40:43], s81 offen offset:2048 lds
    ds_read_b128 v[176:179], v226 offset:49152
    ds_read_b128 v[180:183], v227 offset:49152
    ds_read_b128 v[184:187], v226 offset:57344
    ds_read_b128 v[188:191], v227 offset:57344
    s_waitcnt lgkmcnt(3)
    v_mfma_f32_16x16x32_bf16 v[204:207], v[160:163], v[176:179], v[204:207]
    s_waitcnt lgkmcnt(2)
    v_mfma_f32_16x16x32_bf16 v[204:207], v[164:167], v[180:183], v[204:207]
    s_waitcnt lgkmcnt(1)
    v_mfma_f32_16x16x32_bf16 v[204:207], v[168:171], v[184:187], v[204:207]
    s_waitcnt lgkmcnt(0)
    v_mfma_f32_16x16x32_bf16 v[204:207], v[172:175], v[188:191], v[204:207]
    ds_read_b128 v[160:163], v220 offset:0
    ds_read_b128 v[164:167], v220 offset:4096
    ds_read_b128 v[168:171], v221 offset:0
    ds_read_b128 v[172:175], v221 offset:4096
    s_setprio 2
    s_nop 2
    v_cvt_pk_bf16_f32 v204, v204, v204
    v_and_b32 v204, 0xffff0000, v204
    v_mul_f32 v204, 0xbfb8aa3b, v204
    v_exp_f32 v204, v204
    s_nop 0
    v_add_f32 v204, 1.0, v204
    v_rcp_f32 v204, v204
    s_nop 0
    v_cvt_pk_bf16_f32 v204, v204, v204
    v_and_b32 v204, 0xffff0000, v204
    ds_write_b32 v229, v204 offset:32000
    v_mov_b64 v[192:193], -1
    v_mov_b64 v[194:195], -1
    v_sub_f32 v205, 1.0, v204
    v_cvt_pk_bf16_f32 v205, v205, v205
    v_and_b32 v205, 0xffff0000, v205
    v_max_f32 v205, 0x0d800000, v205
    v_rcp_f32 v205, v205
    s_nop 0
    ds_write_b32 v229, v205 offset:30976
    ds_write_b16 v229, v240 offset:32512
    s_setprio 0
    s_setprio 2
    s_mov_b32 s31, 200000
L_lw_8:
    ds_read_b32 v12, v11 offset:32256
    s_waitcnt lgkmcnt(0)
    v_cmp_gt_i32 vcc, 2, v12
    s_cbranch_vccz L_ok_9
    s_sleep 1
    s_sub_u32 s31, s31, 1
    s_cmp_lg_u32 s31, 0
    s_cbranch_scc1 L_lw_8
L_ok_9:
    s_setprio 0
    s_xor_b32 s81, s70, 1
    s_mul_i32 s81, s81, 88064
    s_add_u32 m0, s80, 0
    s_nop 0
    buffer_load_dwordx4 v208, s[36:39], s81 offen offset:0 lds
    buffer_load_dwordx4 v209, s[36:39], s81 offen offset:1024 lds
    buffer_load_dwordx4 v210, s[36:39], s81 offen offset:2048 lds
    s_add_u32 m0, s80, 3200
    s_nop 0
    buffer_load_dwordx4 v208, s[40:43], s81 offen offset:0 lds
    buffer_load_dwordx4 v209, s[40:43], s81 offen offset:1024 lds
    buffer_load_dwordx4 v210, s[40:43], s81 offen offset:2048 lds
    s_xor_b32 s81, s70, 2
    s_mul_i32 s81, s81, 88064
    s_cmp_gt_u32 s83, 28
    s_cbranch_scc1 L_light
    s_waitcnt vmcnt(6)
    ds_read_b64_tr_b16 v[112:113], v215 offset:0
    ds_read_b64_tr_b16 v[114:115], v215 offset:384
    ds_read_b64_tr_b16 v[116:117], v215 offset:32
    ds_read_b64_tr_b16 v[118:119], v215 offset:416
    ds_read_b64_tr_b16 v[120:121], v215 offset:64
    ds_read_b64_tr_b16 v[122:123], v215 offset:448
    ds_read_b64_tr_b16 v[124:125], v215 offset:1536
    ds_read_b64_tr_b16 v[126:127], v215 offset:1920
    ds_read_b64_tr_b16 v[128:129], v215 offset:1568
    ds_read_b64_tr_b16 v[130:131], v215 offset:1952
    ds_read_b64_tr_b16 v[132:133], v215 offset:1600
    ds_read_b64_tr_b16 v[134:135], v215 offset:1984
    s_waitcnt lgkmcnt(0)
    v_mfma_f32_32x32x16_bf16 v[16:31], v[112:115], v[160:163], 0
    v_mfma_f32_32x32x16_bf16 v[32:47], v[112:115], v[164:167], 0
    v_mfma_f32_32x32x16_bf16 v[48:63], v[116:119], v[160:163], 0
    s_add_u32 m0, s80, 8192
    ds_read_b128 v[176:179], v222 offset:0
    buffer_load_dwordx4 v208, s[36:39], s81 offen offset:0 lds
    ds_read_b128 v[180:183], v222 offset:4096
    buffer_load_dwordx4 v209, s[36:39], s81 offen offset:1024 lds
    buffer_load_dwordx4 v210, s[36:39], s81 offen offset:2048 lds
    s_lshl2_add_u32 s88, s68, s71
    s_lshl3_add_u32 s88, s88, s69
    s_lshl_b32 s88, s88, 11
    s_add_u32 s88, s88, 589824
    v_mfma_f32_32x32x16_bf16 v[64:79], v[116:119], v[164:167], 0
    v_mfma_f32_32x32x16_bf16 v[80:95], v[120:123], v[160:163], 0
    v_mfma_f32_32x32x16_bf16 v[96:111], v[120:123], v[164:167], 0
    s_add_u32 m0, s80, 11392
    ds_read_b128 v[184:187], v223 offset:0
    buffer_load_dwordx4 v208, s[40:43], s81 offen offset:0 lds
    ds_read_b128 v[188:191], v223 offset:4096
    buffer_load_dwordx4 v209, s[40:43], s81 offen offset:1024 lds
    buffer_load_dwordx4 v210, s[40:43], s81 offen offset:2048 lds
    s_xor_b32 s81, s70, 3
    s_mul_i32 s81, s81, 88064
    s_cmp_gt_u32 s83, 28
    s_cselect_b32 s75, 0, 184320
    s_mul_i32 s73, s68, 184320
    s_add_u32 s73, s73, 2686976
    v_mfma_f32_32x32x16_bf16 v[16:31], v[124:127], v[168:171], v[16:31]
    v_mfma_f32_32x32x16_bf16 v[32:47], v[124:127], v[172:175], v[32:47]
    v_mfma_f32_32x32x16_bf16 v[48:63], v[128:131], v[168:171], v[48:63]
    s_waitcnt vmcnt(6)
    ds_read_b64_tr_b16 v[136:137], v214 offset:0
    ds_read_b64_tr_b16 v[138:139], v214 offset:384
    ds_read_b64_tr_b16 v[140:141], v214 offset:32
    ds_read_b64_tr_b16 v[142:143], v214 offset:416
    ds_read_b64_tr_b16 v[144:145], v214 offset:64
    ds_read_b64_tr_b16 v[146:147], v214 offset:448
    s_add_u32 s48, s28, s73
    s_addc_u32 s49, s29, 0
    s_mov_b32 s50, s75
    s_mov_b32 s51, 0x20000
    v_mfma_f32_32x32x16_bf16 v[64:79], v[128:131], v[172:175], v[64:79]
    v_mfma_f32_32x32x16_bf16 v[80:95], v[132:135], v[168:171], v[80:95]
    v_mfma_f32_32x32x16_bf16 v[96:111], v[132:135], v[172:175], v[96:111]
    ds_read_b64_tr_b16 v[148:149], v214 offset:1536
    ds_read_b64_tr_b16 v[150:151], v214 offset:1920
    ds_read_b64_tr_b16 v[152:153], v214 offset:1568
    ds_read_b64_tr_b16 v[154:155], v214 offset:1952
    ds_read_b64_tr_b16 v[156:157], v214 offset:1600
    ds_read_b64_tr_b16 v[158:159], v214 offset:1984
    s_mov_b32 s96, 0xbfb8aa3b
    s_mov_b32 s97, s96
    s_lshr_b32 s75, s71, 1
    s_lshl_b32 s73, s75, 15
    s_sub_u32 s74, 1409024, s73
    s_waitcnt lgkmcnt(8)
    v_mfma_f32_32x32x16_bf16 v[16:31], v[136:139], v[176:179], v[16:31]
    v_mfma_f32_32x32x16_bf16 v[32:47], v[136:139], v[180:183], v[32:47]
    v_mfma_f32_32x32x16_bf16 v[48:63], v[140:143], v[176:179], v[48:63]
    s_waitcnt lgkmcnt(0)
    s_add_u32 m0, s80, 0
    ds_read_b128 v[160:163], v220 offset:8192
    buffer_load_dwordx4 v208, s[36:39], s81 offen offset:0 lds
    ds_read_b128 v[164:167], v220 offset:12288
    buffer_load_dwordx4 v209, s[36:39], s81 offen offset:1024 lds
    buffer_load_dwordx4 v210, s[36:39], s81 offen offset:2048 lds
    s_add_u32 s52, s20, s73
    s_addc_u32 s53, s21, 0
    s_mov_b32 s54, s74
    s_mov_b32 s55, 0x20000
    v_mfma_f32_32x32x16_bf16 v[64:79], v[140:143], v[180:183], v[64:79]
    v_mfma_f32_32x32x16_bf16 v[80:95], v[144:147], v[176:179], v[80:95]
    v_mfma_f32_32x32x16_bf16 v[96:111], v[144:147], v[180:183], v[96:111]
    s_add_u32 m0, s80, 3200
    ds_read_b128 v[168:171], v221 offset:8192
    buffer_load_dwordx4 v208, s[40:43], s81 offen offset:0 lds
    ds_read_b128 v[172:175], v221 offset:12288
    buffer_load_dwordx4 v209, s[40:43], s81 offen offset:1024 lds
    buffer_load_dwordx4 v210, s[40:43], s81 offen offset:2048 lds
    s_xor_b32 s81, s70, 4
    s_mul_i32 s81, s81, 88064
    s_lshl_b32 s73, s75, 14
    s_sub_u32 s74, 524288, s73
    s_add_u32 s56, s12, s73
    s_addc_u32 s57, s13, 0
    v_mfma_f32_32x32x16_bf16 v[16:31], v[148:151], v[184:187], v[16:31]
    v_mfma_f32_32x32x16_bf16 v[32:47], v[148:151], v[188:191], v[32:47]
    v_mfma_f32_32x32x16_bf16 v[48:63], v[152:155], v[184:187], v[48:63]
    s_waitcnt vmcnt(6)
    ds_read_b64_tr_b16 v[112:113], v214 offset:8192
    ds_read_b64_tr_b16 v[114:115], v214 offset:8576
    ds_read_b64_tr_b16 v[116:117], v214 offset:8224
    ds_read_b64_tr_b16 v[118:119], v214 offset:8608
    ds_read_b64_tr_b16 v[120:121], v214 offset:8256
    ds_read_b64_tr_b16 v[122:123], v214 offset:8640
    s_mov_b32 s58, s74
    s_mov_b32 s59, 0x20000
    s_lshl_b32 s79, s75, 30
    s_and_b32 s73, s83, 1
    s_mul_i32 s73, s73, 91648
    s_lshl_b32 s74, s83, 9
    s_add_u32 s90, s73, s74
    v_mfma_f32_32x32x16_bf16 v[64:79], v[152:155], v[188:191], v[64:79]
    v_mfma_f32_32x32x16_bf16 v[80:95], v[156:159], v[184:187], v[80:95]
    v_mfma_f32_32x32x16_bf16 v[96:111], v[156:159], v[188:191], v[96:111]
    ds_read_b64_tr_b16 v[124:125], v214 offset:9728
    ds_read_b64_tr_b16 v[126:127], v214 offset:10112
    ds_read_b64_tr_b16 v[128:129], v214 offset:9760
    ds_read_b64_tr_b16 v[130:131], v214 offset:10144
    ds_read_b64_tr_b16 v[132:133], v214 offset:9792
    ds_read_b64_tr_b16 v[134:135], v214 offset:10176
    s_lshl_b32 s85, s71, 10
    s_add_u32 s85, s85, 57344
    s_waitcnt lgkmcnt(8)
    v_mfma_f32_32x32x16_bf16 v[16:31], v[112:115], v[160:163], v[16:31]
    v_mfma_f32_32x32x16_bf16 v[32:47], v[112:115], v[164:167], v[32:47]
    v_mfma_f32_32x32x16_bf16 v[48:63], v[116:119], v[160:163], v[48:63]
    s_waitcnt lgkmcnt(0)
    s_add_u32 m0, s80, 8192
    ds_read_b128 v[176:179], v222 offset:8192
    buffer_load_dwordx4 v208, s[36:39], s81 offen offset:0 lds
    ds_read_b128 v[180:183], v222 offset:12288
    buffer_load_dwordx4 v209, s[36:39], s81 offen offset:1024 lds
    buffer_load_dwordx4 v210, s[36:39], s81 offen offset:2048 lds
    v_mfma_f32_32x32x16_bf16 v[64:79], v[116:119], v[164:167], v[64:79]
    v_mfma_f32_32x32x16_bf16 v[80:95], v[120:123], v[160:163], v[80:95]
    v_mfma_f32_32x32x16_bf16 v[96:111], v[120:123], v[164:167], v[96:111]
    s_add_u32 m0, s80, 11392
    ds_read_b128 v[184:187], v223 offset:8192
    buffer_load_dwordx4 v208, s[40:43], s81 offen offset:0 lds
    ds_read_b128 v[188:191], v223 offset:12288
    buffer_load_dwordx4 v209, s[40:43], s81 offen offset:1024 lds
    buffer_load_dwordx4 v210, s[40:43], s81 offen offset:2048 lds
    s_xor_b32 s81, s70, 5
    s_mul_i32 s81, s81, 88064
    v_mfma_f32_32x32x16_bf16 v[16:31], v[124:127], v[168:171], v[16:31]
    v_mfma_f32_32x32x16_bf16 v[32:47], v[124:127], v[172:175], v[32:47]
    v_mfma_f32_32x32x16_bf16 v[48:63], v[128:131], v[168:171], v[48:63]
    s_waitcnt vmcnt(6)
    ds_read_b64_tr_b16 v[136:137], v214 offset:0
    ds_read_b64_tr_b16 v[138:139], v214 offset:384
    ds_read_b64_tr_b16 v[140:141], v214 offset:32
    ds_read_b64_tr_b16 v[142:143], v214 offset:416
    ds_read_b64_tr_b16 v[144:145], v214 offset:64
    ds_read_b64_tr_b16 v[146:147], v214 offset:448
    v_mfma_f32_32x32x16_bf16 v[64:79], v[128:131], v[172:175], v[64:79]
    v_mfma_f32_32x32x16_bf16 v[80:95], v[132:135], v[168:171], v[80:95]
    v_mfma_f32_32x32x16_bf16 v[96:111], v[132:135], v[172:175], v[96:111]
    ds_read_b64_tr_b16 v[148:149], v214 offset:1536
    ds_read_b64_tr_b16 v[150:151], v214 offset:1920
    ds_read_b64_tr_b16 v[152:153], v214 offset:1568
    ds_read_b64_tr_b16 v[154:155], v214 offset:1952
    ds_read_b64_tr_b16 v[156:157], v214 offset:1600
    ds_read_b64_tr_b16 v[158:159], v214 offset:1984
    s_waitcnt lgkmcnt(8)
    v_mfma_f32_32x32x16_bf16 v[16:31], v[136:139], v[176:179], v[16:31]
    v_mfma_f32_32x32x16_bf16 v[32:47], v[136:139], v[180:183], v[32:47]
    v_mfma_f32_32x32x16_bf16 v[48:63], v[140:143], v[176:179], v[48:63]
    s_waitcnt lgkmcnt(0)
    s_add_u32 m0, s80, 0
    ds_read_b128 v[160:163], v220 offset:16384
    buffer_load_dwordx4 v208, s[36:39], s81 offen offset:0 lds
    ds_read_b128 v[164:167], v220 offset:20480
    buffer_load_dwordx4 v209, s[36:39], s81 offen offset:1024 lds
    buffer_load_dwordx4 v210, s[36:39], s81 offen offset:2048 lds
    v_mfma_f32_32x32x16_bf16 v[64:79], v[140:143], v[180:183], v[64:79]
    v_mfma_f32_32x32x16_bf16 v[80:95], v[144:147], v[176:179], v[80:95]
    v_mfma_f32_32x32x16_bf16 v[96:111], v[144:147], v[180:183], v[96:111]
    s_add_u32 m0, s80, 3200
    ds_read_b128 v[168:171], v221 offset:16384
    buffer_load_dwordx4 v208, s[40:43], s81 offen offset:0 lds
    ds_read_b128 v[172:175], v221 offset:20480
    buffer_load_dwordx4 v209, s[40:43], s81 offen offset:1024 lds
    buffer_load_dwordx4 v210, s[40:43], s81 offen offset:2048 lds
    s_xor_b32 s81, s70, 6
    s_mul_i32 s81, s81, 88064
    v_mfma_f32_32x32x16_bf16 v[16:31], v[148:151], v[184:187], v[16:31]
    v_mfma_f32_32x32x16_bf16 v[32:47], v[148:151], v[188:191], v[32:47]
    v_mfma_f32_32x32x16_bf16 v[48:63], v[152:155], v[184:187], v[48:63]
    s_waitcnt vmcnt(6)
    ds_read_b64_tr_b16 v[112:113], v214 offset:8192
    ds_read_b64_tr_b16 v[114:115], v214 offset:8576
    ds_read_b64_tr_b16 v[116:117], v214 offset:8224
    ds_read_b64_tr_b16 v[118:119], v214 offset:8608
    ds_read_b64_tr_b16 v[120:121], v214 offset:8256
    ds_read_b64_tr_b16 v[122:123], v214 offset:8640
    v_mfma_f32_32x32x16_bf16 v[64:79], v[152:155], v[188:191], v[64:79]
    v_mfma_f32_32x32x16_bf16 v[80:95], v[156:159], v[184:187], v[80:95]
    v_mfma_f32_32x32x16_bf16 v[96:111], v[156:159], v[188:191], v[96:111]
    ds_read_b64_tr_b16 v[124:125], v214 offset:9728
    ds_read_b64_tr_b16 v[126:127], v214 offset:10112
    ds_read_b64_tr_b16 v[128:129], v214 offset:9760
    ds_read_b64_tr_b16 v[130:131], v214 offset:10144
    ds_read_b64_tr_b16 v[132:133], v214 offset:9792
    ds_read_b64_tr_b16 v[134:135], v214 offset:10176
    s_waitcnt lgkmcnt(8)
    v_mfma_f32_32x32x16_bf16 v[16:31], v[112:115], v[160:163], v[16:31]
    v_mfma_f32_32x32x16_bf16 v[32:47], v[112:115], v[164:167], v[32:47]
    v_mfma_f32_32x32x16_bf16 v[48:63], v[116:119], v[160:163], v[48:63]
    s_waitcnt lgkmcnt(0)
    s_add_u32 m0, s80, 8192
    ds_read_b128 v[176:179], v222 offset:16384
    buffer_load_dwordx4 v208, s[36:39], s81 offen offset:0 lds
    ds_read_b128 v[180:183], v222 offset:20480
    buffer_load_dwordx4 v209, s[36:39], s81 offen offset:1024 lds
    buffer_load_dwordx4 v210, s[36:39], s81 offen offset:2048 lds
    v_mfma_f32_32x32x16_bf16 v[64:79], v[116:119], v[164:167], v[64:79]
    v_mfma_f32_32x32x16_bf16 v[80:95], v[120:123], v[160:163], v[80:95]
    v_mfma_f32_32x32x16_bf16 v[96:111], v[120:123], v[164:167], v[96:111]
    s_add_u32 m0, s80, 11392
    ds_read_b128 v[184:187], v223 offset:16384
    buffer_load_dwordx4 v208, s[40:43], s81 offen offset:0 lds
    ds_read_b128 v[188:191], v223 offset:20480
    buffer_load_dwordx4 v209, s[40:43], s81 offen offset:1024 lds
    buffer_load_dwordx4 v210, s[40:43], s81 offen offset:2048 lds
    s_xor_b32 s81, s70, 7
    s_mul_i32 s81, s81, 88064
    v_mfma_f32_32x32x16_bf16 v[16:31], v[124:127], v[168:171], v[16:31]
    v_mfma_f32_32x32x16_bf16 v[32:47], v[124:127], v[172:175], v[32:47]
    v_mfma_f32_32x32x16_bf16 v[48:63], v[128:131], v[168:171], v[48:63]
    s_waitcnt vmcnt(6)
    ds_read_b64_tr_b16 v[136:137], v214 offset:0
    ds_read_b64_tr_b16 v[138:139], v214 offset:384
    ds_read_b64_tr_b16 v[140:141], v214 offset:32
    ds_read_b64_tr_b16 v[142:143], v214 offset:416
    ds_read_b64_tr_b16 v[144:145], v214 offset:64
    ds_read_b64_tr_b16 v[146:147], v214 offset:448
    v_mfma_f32_32x32x16_bf16 v[64:79], v[128:131], v[172:175], v[64:79]
    v_mfma_f32_32x32x16_bf16 v[80:95], v[132:135], v[168:171], v[80:95]
    v_mfma_f32_32x32x16_bf16 v[96:111], v[132:135], v[172:175], v[96:111]
    ds_read_b64_tr_b16 v[148:149], v214 offset:1536
    ds_read_b64_tr_b16 v[150:151], v214 offset:1920
    ds_read_b64_tr_b16 v[152:153], v214 offset:1568
    ds_read_b64_tr_b16 v[154:155], v214 offset:1952
    ds_read_b64_tr_b16 v[156:157], v214 offset:1600
    ds_read_b64_tr_b16 v[158:159], v214 offset:1984
    s_waitcnt lgkmcnt(8)
    v_mfma_f32_32x32x16_bf16 v[16:31], v[136:139], v[176:179], v[16:31]
    v_mfma_f32_32x32x16_bf16 v[32:47], v[136:139], v[180:183], v[32:47]
    v_mfma_f32_32x32x16_bf16 v[48:63], v[140:143], v[176:179], v[48:63]
    s_waitcnt lgkmcnt(0)
    s_add_u32 m0, s80, 0
    ds_read_b128 v[160:163], v220 offset:24576
    buffer_load_dwordx4 v208, s[36:39], s81 offen offset:0 lds
    ds_read_b128 v[164:167], v220 offset:28672
    buffer_load_dwordx4 v209, s[36:39], s81 offen offset:1024 lds
    buffer_load_dwordx4 v210, s[36:39], s81 offen offset:2048 lds
    v_mfma_f32_32x32x16_bf16 v[64:79], v[140:143], v[180:183], v[64:79]
    v_mfma_f32_32x32x16_bf16 v[80:95], v[144:147], v[176:179], v[80:95]
    v_mfma_f32_32x32x16_bf16 v[96:111], v[144:147], v[180:183], v[96:111]
    s_add_u32 m0, s80, 3200
    ds_read_b128 v[168:171], v221 offset:24576
    buffer_load_dwordx4 v208, s[40:43], s81 offen offset:0 lds
    ds_read_b128 v[172:175], v221 offset:28672
    buffer_load_dwordx4 v209, s[40:43], s81 offen offset:1024 lds
    buffer_load_dwordx4 v210, s[40:43], s81 offen offset:2048 lds
    s_xor_b32 s81, s70, 8
    s_mul_i32 s81, s81, 88064
    v_mfma_f32_32x32x16_bf16 v[16:31], v[148:151], v[184:187], v[16:31]
    v_mfma_f32_32x32x16_bf16 v[32:47], v[148:151], v[188:191], v[32:47]
    v_mfma_f32_32x32x16_bf16 v[48:63], v[152:155], v[184:187], v[48:63]
    s_waitcnt vmcnt(6)
    ds_read_b64_tr_b16 v[112:113], v214 offset:8192
    ds_read_b64_tr_b16 v[114:115], v214 offset:8576
    ds_read_b64_tr_b16 v[116:117], v214 offset:8224
    ds_read_b64_tr_b16 v[118:119], v214 offset:8608
    ds_read_b64_tr_b16 v[120:121], v214 offset:8256
    ds_read_b64_tr_b16 v[122:123], v214 offset:8640
    v_mfma_f32_32x32x16_bf16 v[64:79], v[152:155], v[188:191], v[64:79]
    v_mfma_f32_32x32x16_bf16 v[80:95], v[156:159], v[184:187], v[80:95]
    v_mfma_f32_32x32x16_bf16 v[96:111], v[156:159], v[188:191], v[96:111]
    ds_read_b64_tr_b16 v[124:125], v214 offset:9728
    ds_read_b64_tr_b16 v[126:127], v214 offset:10112
    ds_read_b64_tr_b16 v[128:129], v214 offset:9760
    ds_read_b64_tr_b16 v[130:131], v214 offset:10144
    ds_read_b64_tr_b16 v[132:133], v214 offset:9792
    ds_read_b64_tr_b16 v[134:135], v214 offset:10176
    s_waitcnt lgkmcnt(8)
    v_mfma_f32_32x32x16_bf16 v[16:31], v[112:115], v[160:163], v[16:31]
    v_mfma_f32_32x32x16_bf16 v[32:47], v[112:115], v[164:167], v[32:47]
    v_mfma_f32_32x32x16_bf16 v[48:63], v[116:119], v[160:163], v[48:63]
    s_waitcnt lgkmcnt(0)
    s_add_u32 m0, s80, 8192
    ds_read_b128 v[176:179], v222 offset:24576
    buffer_load_dwordx4 v208, s[36:39], s81 offen offset:0 lds
    ds_read_b128 v[180:183], v222 offset:28672
    buffer_load_dwordx4 v209, s[36:39], s81 offen offset:1024 lds
    buffer_load_dwordx4 v210, s[36:39], s81 offen offset:2048 lds
    v_mfma_f32_32x32x16_bf16 v[64:79], v[116:119], v[164:167], v[64:79]
    v_mfma_f32_32x32x16_bf16 v[80:95], v[120:123], v[160:163], v[80:95]
    v_mfma_f32_32x32x16_bf16 v[96:111], v[120:123], v[164:167], v[96:111]
    s_add_u32 m0, s80, 11392
    ds_read_b128 v[184:187], v223 offset:24576
    buffer_load_dwordx4 v208, s[40:43], s81 offen offset:0 lds
    ds_read_b128 v[188:191], v223 offset:28672
    buffer_load_dwordx4 v209, s[40:43], s81 offen offset:1024 lds
    buffer_load_dwordx4 v210, s[40:43], s81 offen offset:2048 lds
    s_xor_b32 s81, s70, 9
    s_mul_i32 s81, s81, 88064
    v_mfma_f32_32x32x16_bf16 v[16:31], v[124:127], v[168:171], v[16:31]
    v_mfma_f32_32x32x16_bf16 v[32:47], v[124:127], v[172:175], v[32:47]
    v_mfma_f32_32x32x16_bf16 v[48:63], v[128:131], v[168:171], v[48:63]
    s_waitcnt vmcnt(6)
    ds_read_b64_tr_b16 v[136:137], v214 offset:0
    ds_read_b64_tr_b16 v[138:139], v214 offset:384
    ds_read_b64_tr_b16 v[140:141], v214 offset:32
    ds_read_b64_tr_b16 v[142:143], v214 offset:416
    ds_read_b64_tr_b16 v[144:145], v214 offset:64
    ds_read_b64_tr_b16 v[146:147], v214 offset:448
    v_mfma_f32_32x32x16_bf16 v[64:79], v[128:131], v[172:175], v[64:79]
    v_mfma_f32_32x32x16_bf16 v[80:95], v[132:135], v[168:171], v[80:95]
    v_mfma_f32_32x32x16_bf16 v[96:111], v[132:135], v[172:175], v[96:111]
    ds_read_b64_tr_b16 v[148:149], v214 offset:1536
    ds_read_b64_tr_b16 v[150:151], v214 offset:1920
    ds_read_b64_tr_b16 v[152:153], v214 offset:1568
    ds_read_b64_tr_b16 v[154:155], v214 offset:1952
    ds_read_b64_tr_b16 v[156:157], v214 offset:1600
    ds_read_b64_tr_b16 v[158:159], v214 offset:1984
    s_waitcnt lgkmcnt(8)
    v_mfma_f32_32x32x16_bf16 v[16:31], v[136:139], v[176:179], v[16:31]
    v_mfma_f32_32x32x16_bf16 v[32:47], v[136:139], v[180:183], v[32:47]
    v_mfma_f32_32x32x16_bf16 v[48:63], v[140:143], v[176:179], v[48:63]
    s_waitcnt lgkmcnt(0)
    s_add_u32 m0, s80, 0
    ds_read_b128 v[160:163], v220 offset:32768
    buffer_load_dwordx4 v208, s[36:39], s81 offen offset:0 lds
    ds_read_b128 v[164:167], v220 offset:36864
    buffer_load_dwordx4 v209, s[36:39], s81 offen offset:1024 lds
    buffer_load_dwordx4 v210, s[36:39], s81 offen offset:2048 lds
    v_mfma_f32_32x32x16_bf16 v[64:79], v[140:143], v[180:183], v[64:79]
    v_mfma_f32_32x32x16_bf16 v[80:95], v[144:147], v[176:179], v[80:95]
    v_mfma_f32_32x32x16_bf16 v[96:111], v[144:147], v[180:183], v[96:111]
    s_add_u32 m0, s80, 3200
    ds_read_b128 v[168:171], v221 offset:32768
    buffer_load_dwordx4 v208, s[40:43], s81 offen offset:0 lds
    ds_read_b128 v[172:175], v221 offset:36864
    buffer_load_dwordx4 v209, s[40:43], s81 offen offset:1024 lds
    buffer_load_dwordx4 v210, s[40:43], s81 offen offset:2048 lds
    s_xor_b32 s81, s70, 10
    s_mul_i32 s81, s81, 88064
    v_mfma_f32_32x32x16_bf16 v[16:31], v[148:151], v[184:187], v[16:31]
    v_mfma_f32_32x32x16_bf16 v[32:47], v[148:151], v[188:191], v[32:47]
    v_mfma_f32_32x32x16_bf16 v[48:63], v[152:155], v[184:187], v[48:63]
    s_waitcnt vmcnt(6)
    ds_read_b64_tr_b16 v[112:113], v214 offset:8192
    ds_read_b64_tr_b16 v[114:115], v214 offset:8576
    ds_read_b64_tr_b16 v[116:117], v214 offset:8224
    ds_read_b64_tr_b16 v[118:119], v214 offset:8608
    ds_read_b64_tr_b16 v[120:121], v214 offset:8256
    ds_read_b64_tr_b16 v[122:123], v214 offset:8640
    v_mfma_f32_32x32x16_bf16 v[64:79], v[152:155], v[188:191], v[64:79]
    v_mfma_f32_32x32x16_bf16 v[80:95], v[156:159], v[184:187], v[80:95]
    v_mfma_f32_32x32x16_bf16 v[96:111], v[156:159], v[188:191], v[96:111]
    ds_read_b64_tr_b16 v[124:125], v214 offset:9728
    ds_read_b64_tr_b16 v[126:127], v214 offset:10112
    ds_read_b64_tr_b16 v[128:129], v214 offset:9760
    ds_read_b64_tr_b16 v[130:131], v214 offset:10144
    ds_read_b64_tr_b16 v[132:133], v214 offset:9792
    ds_read_b64_tr_b16 v[134:135], v214 offset:10176
    s_waitcnt lgkmcnt(8)
    v_mfma_f32_32x32x16_bf16 v[16:31], v[112:115], v[160:163], v[16:31]
    v_mfma_f32_32x32x16_bf16 v[32:47], v[112:115], v[164:167], v[32:47]
    v_mfma_f32_32x32x16_bf16 v[48:63], v[116:119], v[160:163], v[48:63]
    s_waitcnt lgkmcnt(0)
    s_add_u32 m0, s80, 8192
    ds_read_b128 v[176:179], v222 offset:32768
    buffer_load_dwordx4 v208, s[36:39], s81 offen offset:0 lds
    ds_read_b128 v[180:183], v222 offset:36864
    buffer_load_dwordx4 v209, s[36:39], s81 offen offset:1024 lds
    buffer_load_dwordx4 v210, s[36:39], s81 offen offset:2048 lds
    v_mfma_f32_32x32x16_bf16 v[64:79], v[116:119], v[164:167], v[64:79]
    v_mfma_f32_32x32x16_bf16 v[80:95], v[120:123], v[160:163], v[80:95]
    v_mfma_f32_32x32x16_bf16 v[96:111], v[120:123], v[164:167], v[96:111]
    s_add_u32 m0, s80, 11392
    ds_read_b128 v[184:187], v223 offset:32768
    buffer_load_dwordx4 v208, s[40:43], s81 offen offset:0 lds
    ds_read_b128 v[188:191], v223 offset:36864
    buffer_load_dwordx4 v209, s[40:43], s81 offen offset:1024 lds
    buffer_load_dwordx4 v210, s[40:43], s81 offen offset:2048 lds
    s_xor_b32 s81, s70, 11
    s_mul_i32 s81, s81, 88064
    v_mfma_f32_32x32x16_bf16 v[16:31], v[124:127], v[168:171], v[16:31]
    v_mfma_f32_32x32x16_bf16 v[32:47], v[124:127], v[172:175], v[32:47]
    v_mfma_f32_32x32x16_bf16 v[48:63], v[128:131], v[168:171], v[48:63]
    s_waitcnt vmcnt(6)
    ds_read_b64_tr_b16 v[136:137], v214 offset:0
    ds_read_b64_tr_b16 v[138:139], v214 offset:384
    ds_read_b64_tr_b16 v[140:141], v214 offset:32
    ds_read_b64_tr_b16 v[142:143], v214 offset:416
    ds_read_b64_tr_b16 v[144:145], v214 offset:64
    ds_read_b64_tr_b16 v[146:147], v214 offset:448
    v_mfma_f32_32x32x16_bf16 v[64:79], v[128:131], v[172:175], v[64:79]
    v_mfma_f32_32x32x16_bf16 v[80:95], v[132:135], v[168:171], v[80:95]
    v_mfma_f32_32x32x16_bf16 v[96:111], v[132:135], v[172:175], v[96:111]
    ds_read_b64_tr_b16 v[148:149], v214 offset:1536
    ds_read_b64_tr_b16 v[150:151], v214 offset:1920
    ds_read_b64_tr_b16 v[152:153], v214 offset:1568
    ds_read_b64_tr_b16 v[154:155], v214 offset:1952
    ds_read_b64_tr_b16 v[156:157], v214 offset:1600
    ds_read_b64_tr_b16 v[158:159], v214 offset:1984
    buffer_store_dwordx4 v[192:195], v10, s[44:47], s88 offen offset:0 sc1
    buffer_store_dwordx4 v[192:195], v10, s[44:47], s88 offen offset:1024 sc1
    s_waitcnt lgkmcnt(8)
    v_mfma_f32_32x32x16_bf16 v[16:31], v[136:139], v[176:179], v[16:31]
    v_mfma_f32_32x32x16_bf16 v[32:47], v[136:139], v[180:183], v[32:47]
    v_mfma_f32_32x32x16_bf16 v[48:63], v[140:143], v[176:179], v[48:63]
    s_waitcnt lgkmcnt(0)
    s_add_u32 m0, s80, 0
    ds_read_b128 v[160:163], v220 offset:40960
    buffer_load_dwordx4 v208, s[36:39], s81 offen offset:0 lds
    ds_read_b128 v[164:167], v220 offset:45056
    buffer_load_dwordx4 v209, s[36:39], s81 offen offset:1024 lds
    buffer_load_dwordx4 v210, s[36:39], s81 offen offset:2048 lds
    v_mfma_f32_32x32x16_bf16 v[64:79], v[140:143], v[180:183], v[64:79]
    v_mfma_f32_32x32x16_bf16 v[80:95], v[144:147], v[176:179], v[80:95]
    v_mfma_f32_32x32x16_bf16 v[96:111], v[144:147], v[180:183], v[96:111]
    s_add_u32 m0, s80, 3200
    ds_read_b128 v[168:171], v221 offset:40960
    buffer_load_dwordx4 v208, s[40:43], s81 offen offset:0 lds
    ds_read_b128 v[172:175], v221 offset:45056
    buffer_load_dwordx4 v209, s[40:43], s81 offen offset:1024 lds
    buffer_load_dwordx4 v210, s[40:43], s81 offen offset:2048 lds
    s_xor_b32 s81, s70, 12
    s_mul_i32 s81, s81, 88064
    v_mfma_f32_32x32x16_bf16 v[16:31], v[148:151], v[184:187], v[16:31]
    v_mfma_f32_32x32x16_bf16 v[32:47], v[148:151], v[188:191], v[32:47]
    v_mfma_f32_32x32x16_bf16 v[48:63], v[152:155], v[184:187], v[48:63]
    s_waitcnt vmcnt(8)
    ds_read_b64_tr_b16 v[112:113], v214 offset:8192
    ds_read_b64_tr_b16 v[114:115], v214 offset:8576
    ds_read_b64_tr_b16 v[116:117], v214 offset:8224
    ds_read_b64_tr_b16 v[118:119], v214 offset:8608
    ds_read_b64_tr_b16 v[120:121], v214 offset:8256
    ds_read_b64_tr_b16 v[122:123], v214 offset:8640
    v_mfma_f32_32x32x16_bf16 v[64:79], v[152:155], v[188:191], v[64:79]
    v_mfma_f32_32x32x16_bf16 v[80:95], v[156:159], v[184:187], v[80:95]
    v_mfma_f32_32x32x16_bf16 v[96:111], v[156:159], v[188:191], v[96:111]
    ds_read_b64_tr_b16 v[124:125], v214 offset:9728
    ds_read_b64_tr_b16 v[126:127], v214 offset:10112
    ds_read_b64_tr_b16 v[128:129], v214 offset:9760
    ds_read_b64_tr_b16 v[130:131], v214 offset:10144
    ds_read_b64_tr_b16 v[132:133], v214 offset:9792
    ds_read_b64_tr_b16 v[134:135], v214 offset:10176
    s_waitcnt lgkmcnt(8)
    v_mfma_f32_32x32x16_bf16 v[16:31], v[112:115], v[160:163], v[16:31]
    v_mfma_f32_32x32x16_bf16 v[32:47], v[112:115], v[164:167], v[32:47]
    v_mfma_f32_32x32x16_bf16 v[48:63], v[116:119], v[160:163], v[48:63]
    s_waitcnt lgkmcnt(0)
    s_add_u32 m0, s80, 8192
    ds_read_b128 v[176:179], v222 offset:40960
    buffer_load_dwordx4 v208, s[36:39], s81 offen offset:0 lds
    ds_read_b128 v[180:183], v222 offset:45056
    buffer_load_dwordx4 v209, s[36:39], s81 offen offset:1024 lds
    buffer_load_dwordx4 v210, s[36:39], s81 offen offset:2048 lds
    v_mfma_f32_32x32x16_bf16 v[64:79], v[116:119], v[164:167], v[64:79]
    v_mfma_f32_32x32x16_bf16 v[80:95], v[120:123], v[160:163], v[80:95]
    v_mfma_f32_32x32x16_bf16 v[96:111], v[120:123], v[164:167], v[96:111]
    s_add_u32 m0, s80, 11392
    ds_read_b128 v[184:187], v223 offset:40960
    buffer_load_dwordx4 v208, s[40:43], s81 offen offset:0 lds
    ds_read_b128 v[188:191], v223 offset:45056
    buffer_load_dwordx4 v209, s[40:43], s81 offen offset:1024 lds
    buffer_load_dwordx4 v210, s[40:43], s81 offen offset:2048 lds
    s_xor_b32 s81, s70, 13
    s_mul_i32 s81, s81, 88064
    v_mfma_f32_32x32x16_bf16 v[16:31], v[124:127], v[168:171], v[16:31]
    v_mfma_f32_32x32x16_bf16 v[32:47], v[124:127], v[172:175], v[32:47]
    v_mfma_f32_32x32x16_bf16 v[48:63], v[128:131], v[168:171], v[48:63]
    s_waitcnt vmcnt(6)
    ds_read_b64_tr_b16 v[136:137], v214 offset:0
    ds_read_b64_tr_b16 v[138:139], v214 offset:384
    ds_read_b64_tr_b16 v[140:141], v214 offset:32
    ds_read_b64_tr_b16 v[142:143], v214 offset:416
    ds_read_b64_tr_b16 v[144:145], v214 offset:64
    ds_read_b64_tr_b16 v[146:147], v214 offset:448
    v_mfma_f32_32x32x16_bf16 v[64:79], v[128:131], v[172:175], v[64:79]
    v_mfma_f32_32x32x16_bf16 v[80:95], v[132:135], v[168:171], v[80:95]
    v_mfma_f32_32x32x16_bf16 v[96:111], v[132:135], v[172:175], v[96:111]
    ds_read_b64_tr_b16 v[148:149], v214 offset:1536
    ds_read_b64_tr_b16 v[150:151], v214 offset:1920
    ds_read_b64_tr_b16 v[152:153], v214 offset:1568
    ds_read_b64_tr_b16 v[154:155], v214 offset:1952
    ds_read_b64_tr_b16 v[156:157], v214 offset:1600
    ds_read_b64_tr_b16 v[158:159], v214 offset:1984
    s_waitcnt lgkmcnt(8)
    v_mfma_f32_32x32x16_bf16 v[16:31], v[136:139], v[176:179], v[16:31]
    v_mfma_f32_32x32x16_bf16 v[32:47], v[136:139], v[180:183], v[32:47]
    v_mfma_f32_32x32x16_bf16 v[48:63], v[140:143], v[176:179], v[48:63]
    s_waitcnt lgkmcnt(0)
    s_add_u32 m0, s80, 0
    ds_read_b128 v[160:163], v220 offset:49152
    buffer_load_dwordx4 v208, s[36:39], s81 offen offset:0 lds
    ds_read_b128 v[164:167], v220 offset:53248
    buffer_load_dwordx4 v209, s[36:39], s81 offen offset:1024 lds
    buffer_load_dwordx4 v210, s[36:39], s81 offen offset:2048 lds
    v_mfma_f32_32x32x16_bf16 v[64:79], v[140:143], v[180:183], v[64:79]
    v_mfma_f32_32x32x16_bf16 v[80:95], v[144:147], v[176:179], v[80:95]
    v_mfma_f32_32x32x16_bf16 v[96:111], v[144:147], v[180:183], v[96:111]
    s_add_u32 m0, s80, 3200
    ds_read_b128 v[168:171], v221 offset:49152
    buffer_load_dwordx4 v208, s[40:43], s81 offen offset:0 lds
    ds_read_b128 v[172:175], v221 offset:53248
    buffer_load_dwordx4 v209, s[40:43], s81 offen offset:1024 lds
    buffer_load_dwordx4 v210, s[40:43], s81 offen offset:2048 lds
    s_xor_b32 s81, s70, 14
    s_mul_i32 s81, s81, 88064
    v_mfma_f32_32x32x16_bf16 v[16:31], v[148:151], v[184:187], v[16:31]
    v_mfma_f32_32x32x16_bf16 v[32:47], v[148:151], v[188:191], v[32:47]
    v_mfma_f32_32x32x16_bf16 v[48:63], v[152:155], v[184:187], v[48:63]
    s_waitcnt vmcnt(6)
    ds_read_b64_tr_b16 v[112:113], v214 offset:8192
    ds_read_b64_tr_b16 v[114:115], v214 offset:8576
    ds_read_b64_tr_b16 v[116:117], v214 offset:8224
    ds_read_b64_tr_b16 v[118:119], v214 offset:8608
    ds_read_b64_tr_b16 v[120:121], v214 offset:8256
    ds_read_b64_tr_b16 v[122:123], v214 offset:8640
    v_mfma_f32_32x32x16_bf16 v[64:79], v[152:155], v[188:191], v[64:79]
    v_mfma_f32_32x32x16_bf16 v[80:95], v[156:159], v[184:187], v[80:95]
    v_mfma_f32_32x32x16_bf16 v[96:111], v[156:159], v[188:191], v[96:111]
    ds_read_b64_tr_b16 v[124:125], v214 offset:9728
    ds_read_b64_tr_b16 v[126:127], v214 offset:10112
    ds_read_b64_tr_b16 v[128:129], v214 offset:9760
    ds_read_b64_tr_b16 v[130:131], v214 offset:10144
    ds_read_b64_tr_b16 v[132:133], v214 offset:9792
    ds_read_b64_tr_b16 v[134:135], v214 offset:10176
    s_waitcnt lgkmcnt(8)
    v_mfma_f32_32x32x16_bf16 v[16:31], v[112:115], v[160:163], v[16:31]
    v_mfma_f32_32x32x16_bf16 v[32:47], v[112:115], v[164:167], v[32:47]
    v_mfma_f32_32x32x16_bf16 v[48:63], v[116:119], v[160:163], v[48:63]
    s_waitcnt lgkmcnt(0)
    s_add_u32 m0, s80, 8192
    ds_read_b128 v[176:179], v222 offset:49152
    buffer_load_dwordx4 v208, s[36:39], s81 offen offset:0 lds
    ds_read_b128 v[180:183], v222 offset:53248
    buffer_load_dwordx4 v209, s[36:39], s81 offen offset:1024 lds
    buffer_load_dwordx4 v210, s[36:39], s81 offen offset:2048 lds
    v_mfma_f32_32x32x16_bf16 v[64:79], v[116:119], v[164:167], v[64:79]
    v_mfma_f32_32x32x16_bf16 v[80:95], v[120:123], v[160:163], v[80:95]
    v_mfma_f32_32x32x16_bf16 v[96:111], v[120:123], v[164:167], v[96:111]
    s_add_u32 m0, s80, 11392
    ds_read_b128 v[184:187], v223 offset:49152
    buffer_load_dwordx4 v208, s[40:43], s81 offen offset:0 lds
    ds_read_b128 v[188:191], v223 offset:53248
    buffer_load_dwordx4 v209, s[40:43], s81 offen offset:1024 lds
    buffer_load_dwordx4 v210, s[40:43], s81 offen offset:2048 lds
    s_xor_b32 s81, s70, 15
    s_mul_i32 s81, s81, 88064
    v_mfma_f32_32x32x16_bf16 v[16:31], v[124:127], v[168:171], v[16:31]
    v_mfma_f32_32x32x16_bf16 v[32:47], v[124:127], v[172:175], v[32:47]
    v_mfma_f32_32x32x16_bf16 v[48:63], v[128:131], v[168:171], v[48:63]
    s_waitcnt vmcnt(6)
    ds_read_b64_tr_b16 v[136:137], v214 offset:0
    ds_read_b64_tr_b16 v[138:139], v214 offset:384
    ds_read_b64_tr_b16 v[140:141], v214 offset:32
    ds_read_b64_tr_b16 v[142:143], v214 offset:416
    ds_read_b64_tr_b16 v[144:145], v214 offset:64
    ds_read_b64_tr_b16 v[146:147], v214 offset:448
    v_mfma_f32_32x32x16_bf16 v[64:79], v[128:131], v[172:175], v[64:79]
    v_mfma_f32_32x32x16_bf16 v[80:95], v[132:135], v[168:171], v[80:95]
    v_mfma_f32_32x32x16_bf16 v[96:111], v[132:135], v[172:175], v[96:111]
    ds_read_b64_tr_b16 v[148:149], v214 offset:1536
    ds_read_b64_tr_b16 v[150:151], v214 offset:1920
    ds_read_b64_tr_b16 v[152:153], v214 offset:1568
    ds_read_b64_tr_b16 v[154:155], v214 offset:1952
    ds_read_b64_tr_b16 v[156:157], v214 offset:1600
    ds_read_b64_tr_b16 v[158:159], v214 offset:1984
    ds_read_b32 v12, v11 offset:32512
    ds_read2_b32 v[218:219], v13 offset1:32
    s_waitcnt lgkmcnt(10)
    v_mfma_f32_32x32x16_bf16 v[16:31], v[136:139], v[176:179], v[16:31]
    v_mfma_f32_32x32x16_bf16 v[32:47], v[136:139], v[180:183], v[32:47]
    v_mfma_f32_32x32x16_bf16 v[48:63], v[140:143], v[176:179], v[48:63]
    s_waitcnt lgkmcnt(2)
    s_add_u32 m0, s80, 0
    ds_read_b128 v[160:163], v220 offset:57344
    buffer_load_dwordx4 v208, s[36:39], s81 offen offset:0 lds
    ds_read_b128 v[164:167], v220 offset:61440
    buffer_load_dwordx4 v209, s[36:39], s81 offen offset:1024 lds
    buffer_load_dwordx4 v210, s[36:39], s81 offen offset:2048 lds
    v_mfma_f32_32x32x16_bf16 v[64:79], v[140:143], v[180:183], v[64:79]
    v_mfma_f32_32x32x16_bf16 v[80:95], v[144:147], v[176:179], v[80:95]
    v_mfma_f32_32x32x16_bf16 v[96:111], v[144:147], v[180:183], v[96:111]
    s_add_u32 m0, s80, 3200
    ds_read_b128 v[168:171], v221 offset:57344
    buffer_load_dwordx4 v208, s[40:43], s81 offen offset:0 lds
    ds_read_b128 v[172:175], v221 offset:61440
    buffer_load_dwordx4 v209, s[40:43], s81 offen offset:1024 lds
    buffer_load_dwordx4 v210, s[40:43], s81 offen offset:2048 lds
    v_mfma_f32_32x32x16_bf16 v[16:31], v[148:151], v[184:187], v[16:31]
    v_mfma_f32_32x32x16_bf16 v[32:47], v[148:151], v[188:191], v[32:47]
    v_mfma_f32_32x32x16_bf16 v[48:63], v[152:155], v[184:187], v[48:63]
    s_waitcnt vmcnt(6)
    ds_read_b64_tr_b16 v[112:113], v214 offset:8192
    ds_read_b64_tr_b16 v[114:115], v214 offset:8576
    ds_read_b64_tr_b16 v[116:117], v214 offset:8224
    ds_read_b64_tr_b16 v[118:119], v214 offset:8608
    ds_read_b64_tr_b16 v[120:121], v214 offset:8256
    ds_read_b64_tr_b16 v[122:123], v214 offset:8640
    v_mfma_f32_32x32x16_bf16 v[64:79], v[152:155], v[188:191], v[64:79]
    v_mfma_f32_32x32x16_bf16 v[80:95], v[156:159], v[184:187], v[80:95]
    v_mfma_f32_32x32x16_bf16 v[96:111], v[156:159], v[188:191], v[96:111]
    s_setprio 2
    s_waitcnt lgkmcnt(10)
    v_cmp_gt_i32 vcc, 1, v12
    s_cbranch_vccnz L_cretry
L_cgot:
    s_setprio 0
    ds_read_b64_tr_b16 v[124:125], v214 offset:9728
    ds_read_b64_tr_b16 v[126:127], v214 offset:10112
    ds_read_b64_tr_b16 v[128:129], v214 offset:9760
    ds_read_b64_tr_b16 v[130:131], v214 offset:10144
    ds_read_b64_tr_b16 v[132:133], v214 offset:9792
    ds_read_b64_tr_b16 v[134:135], v214 offset:10176
    s_waitcnt lgkmcnt(8)
    v_mfma_f32_32x32x16_bf16 v[16:31], v[112:115], v[160:163], v[16:31]
    v_mfma_f32_32x32x16_bf16 v[32:47], v[112:115], v[164:167], v[32:47]
    v_mfma_f32_32x32x16_bf16 v[48:63], v[116:119], v[160:163], v[48:63]
    ds_read_b128 v[176:179], v222 offset:57344
    ds_read_b128 v[180:183], v222 offset:61440
    s_lshl_b32 s73, s83, 5
    s_add_u32 s95, s95, s73
    s_mul_i32 s74, s71, 46080
    s_add_u32 s64, s48, s74
    s_addc_u32 s65, s49, 0
    s_mov_b32 s66, 46080
    s_mov_b32 s67, 0x20000
    s_mov_b64 s[60:61], s[24:25]
    s_mov_b32 s62, 2097152
    s_mov_b32 s63, 0x20000
    s_mov_b64 s[40:41], s[28:29]
    s_mov_b32 s42, 0
    s_mov_b32 s43, 0x20000
    s_lshl_b32 s73, s68, 16
    s_lshl_b32 s74, s71, 14
    s_add_u32 s74, s73, s74
    s_add_u32 s36, s74, 589824
    s_add_u32 s37, s74, 593920
    s_add_u32 s38, s74, 598016
    s_add_u32 s39, s74, 602112
    s_and_b32 s74, s71, 1
    s_lshl_b32 s74, s74, 15
    s_add_u32 s73, s73, s74
    s_lshl_b32 s74, s69, 7
    s_add_u32 s73, s73, s74
    s_lshr_b32 s74, s71, 1
    s_lshl_b32 s74, s74, 14
    s_add_u32 s77, s73, s74
    s_add_u32 s78, s77, 8192
    s_waitcnt lgkmcnt(8)
    v_mfma_f32_32x32x16_bf16 v[64:79], v[116:119], v[164:167], v[64:79]
    v_mfma_f32_32x32x16_bf16 v[80:95], v[120:123], v[160:163], v[80:95]
    v_mfma_f32_32x32x16_bf16 v[96:111], v[120:123], v[164:167], v[96:111]
    ds_read_b128 v[184:187], v223 offset:57344
    ds_read_b128 v[188:191], v223 offset:61440
    s_waitcnt lgkmcnt(6)
    v_mfma_f32_32x32x16_bf16 v[16:31], v[124:127], v[168:171], v[16:31]
    v_mfma_f32_32x32x16_bf16 v[32:47], v[124:127], v[172:175], v[32:47]
    v_mfma_f32_32x32x16_bf16 v[48:63], v[128:131], v[168:171], v[48:63]
    s_waitcnt vmcnt(0)
    ds_read_b64_tr_b16 v[136:137], v214 offset:0
    ds_read_b64_tr_b16 v[138:139], v214 offset:384
    ds_read_b64_tr_b16 v[140:141], v214 offset:32
    ds_read_b64_tr_b16 v[142:143], v214 offset:416
    ds_read_b64_tr_b16 v[144:145], v214 offset:64
    ds_read_b64_tr_b16 v[146:147], v214 offset:448
    s_waitcnt lgkmcnt(10)
    v_mfma_f32_32x32x16_bf16 v[64:79], v[128:131], v[172:175], v[64:79]
    v_mfma_f32_32x32x16_bf16 v[80:95], v[132:135], v[168:171], v[80:95]
    v_mfma_f32_32x32x16_bf16 v[96:111], v[132:135], v[172:175], v[96:111]
    ds_read_b64_tr_b16 v[148:149], v214 offset:1536
    ds_read_b64_tr_b16 v[150:151], v214 offset:1920
    ds_read_b64_tr_b16 v[152:153], v214 offset:1568
    ds_read_b64_tr_b16 v[154:155], v214 offset:1952
    ds_read_b64_tr_b16 v[156:157], v214 offset:1600
    ds_read_b64_tr_b16 v[158:159], v214 offset:1984
    s_waitcnt lgkmcnt(8)
    v_mfma_f32_32x32x16_bf16 v[16:31], v[136:139], v[176:179], v[16:31]
    v_mfma_f32_32x32x16_bf16 v[32:47], v[136:139], v[180:183], v[32:47]
    v_mfma_f32_32x32x16_bf16 v[48:63], v[140:143], v[176:179], v[48:63]
    s_waitcnt lgkmcnt(6)
    v_mfma_f32_32x32x16_bf16 v[64:79], v[140:143], v[180:183], v[64:79]
    v_mfma_f32_32x32x16_bf16 v[80:95], v[144:147], v[176:179], v[80:95]
    v_mfma_f32_32x32x16_bf16 v[96:111], v[144:147], v[180:183], v[96:111]
    s_waitcnt lgkmcnt(2)
    v_mfma_f32_32x32x16_bf16 v[16:31], v[148:151], v[184:187], v[16:31]
    v_mfma_f32_32x32x16_bf16 v[32:47], v[148:151], v[188:191], v[32:47]
    v_mfma_f32_32x32x16_bf16 v[48:63], v[152:155], v[184:187], v[48:63]
    s_waitcnt lgkmcnt(0)
    v_mfma_f32_32x32x16_bf16 v[64:79], v[152:155], v[188:191], v[64:79]
    v_mfma_f32_32x32x16_bf16 v[80:95], v[156:159], v[184:187], v[80:95]
    v_mfma_f32_32x32x16_bf16 v[96:111], v[156:159], v[188:191], v[96:111]
L_Bh:
    s_waitcnt vmcnt(0) lgkmcnt(0)
    ds_write_b16_d16_hi v229, v240 offset:32512
    s_setprio 2
    buffer_load_dword v200, v10, s[44:47], s88 offen offset:1024 sc1
    s_nop 4
    v_pk_mul_f32 v[192:193], v[16:17], s[96:97]
    v_pk_mul_f32 v[194:195], v[18:19], s[96:97]
    v_pk_mul_f32 v[196:197], v[20:21], s[96:97]
    v_pk_mul_f32 v[198:199], v[22:23], s[96:97]
    v_exp_f32 v192, v192
    v_exp_f32 v193, v193
    v_exp_f32 v194, v194
    v_exp_f32 v195, v195
    v_exp_f32 v196, v196
    v_exp_f32 v197, v197
    v_exp_f32 v198, v198
    v_exp_f32 v199, v199
    v_pk_mul_f32 v[16:17], v[16:17], v[24:25]
    v_pk_mul_f32 v[18:19], v[18:19], v[26:27]
    v_pk_mul_f32 v[20:21], v[20:21], v[28:29]
    v_pk_mul_f32 v[22:23], v[22:23], v[30:31]
    v_pk_fma_f32 v[192:193], v[192:193], v[218:219], v[218:219] op_sel:[0,0,0] op_sel_hi:[1,0,0]
    v_pk_fma_f32 v[194:195], v[194:195], v[218:219], v[218:219] op_sel:[0,0,0] op_sel_hi:[1,0,0]
    v_pk_fma_f32 v[196:197], v[196:197], v[218:219], v[218:219] op_sel:[0,0,0] op_sel_hi:[1,0,0]
    v_pk_fma_f32 v[198:199], v[198:199], v[218:219], v[218:219] op_sel:[0,0,0] op_sel_hi:[1,0,0]
    v_rcp_f32 v192, v192
    v_rcp_f32 v193, v193
    v_rcp_f32 v194, v194
    v_rcp_f32 v195, v195
    v_rcp_f32 v196, v196
    v_rcp_f32 v197, v197
    v_rcp_f32 v198, v198
    v_rcp_f32 v199, v199
    v_pk_mul_f32 v[16:17], v[16:17], v[192:193]
    v_pk_mul_f32 v[18:19], v[18:19], v[194:195]
    v_pk_mul_f32 v[20:21], v[20:21], v[196:197]
    v_pk_mul_f32 v[22:23], v[22:23], v[198:199]
    v_cvt_pk_bf16_f32 v24, v16, v17
    v_cvt_pk_bf16_f32 v25, v18, v19
    v_cvt_pk_bf16_f32 v26, v20, v21
    v_cvt_pk_bf16_f32 v27, v22, v23
    s_add_u32 s91, s90, 0
    buffer_store_dwordx4 v[24:27], v10, s[48:51], s91 offen sc1
    s_mov_b32 s31, 200000
L_lw_10:
    ds_read_b32 v193, v11 offset:32256
    s_waitcnt lgkmcnt(0)
    v_cmp_gt_i32 vcc, 3, v193
    s_cbranch_vccz L_ok_11
    s_sleep 1
    s_sub_u32 s31, s31, 1
    s_cmp_lg_u32 s31, 0
    s_cbranch_scc1 L_lw_10
L_ok_11:
    s_mov_b32 s31, 200000
L_lw_12:
    ds_read_b32 v192, v11 offset:32512
    s_waitcnt lgkmcnt(0)
    v_cmp_gt_i32 vcc, 2, v192
    s_cbranch_vccz L_ok_13
    s_sleep 1
    s_sub_u32 s31, s31, 1
    s_cmp_lg_u32 s31, 0
    s_cbranch_scc1 L_lw_12
L_ok_13:
    v_cmp_lt_u32 vcc, 64, v193
    s_or_b32 s87, vcc_lo, vcc_hi
    s_cselect_b64 vcc, -1, 0
    v_cndmask_b32 v232, v232, v216, vcc
    s_lshr_b32 s73, s68, 3
    s_xor_b32 s73, s73, 0
    s_mul_i32 s92, s73, 98304
    s_lshl_b32 s73, s73, 12
    s_add_u32 s93, s73, s85
    s_add_u32 m0, s93, 0
    s_add_u32 s73, s92, 0
    buffer_load_dwordx4 v252, s[52:55], s73 offen lds
    s_add_u32 m0, s93, 16384
    s_add_u32 s73, s92, 393216
    buffer_load_dwordx4 v252, s[52:55], s73 offen lds
    v_pk_mul_f32 v[192:193], v[32:33], s[96:97]
    v_pk_mul_f32 v[194:195], v[34:35], s[96:97]
    v_pk_mul_f32 v[196:197], v[36:37], s[96:97]
    v_pk_mul_f32 v[198:199], v[38:39], s[96:97]
    v_exp_f32 v192, v192
    v_exp_f32 v193, v193
    v_exp_f32 v194, v194
    v_exp_f32 v195, v195
    v_exp_f32 v196, v196
    v_exp_f32 v197, v197
    v_exp_f32 v198, v198
    v_exp_f32 v199, v199
    v_pk_mul_f32 v[32:33], v[32:33], v[40:41]
    v_pk_mul_f32 v[34:35], v[34:35], v[42:43]
    v_pk_mul_f32 v[36:37], v[36:37], v[44:45]
    v_pk_mul_f32 v[38:39], v[38:39], v[46:47]
    v_pk_fma_f32 v[192:193], v[192:193], v[218:219], v[218:219] op_sel:[0,1,1] op_sel_hi:[1,1,1]
    v_pk_fma_f32 v[194:195], v[194:195], v[218:219], v[218:219] op_sel:[0,1,1] op_sel_hi:[1,1,1]
    v_pk_fma_f32 v[196:197], v[196:197], v[218:219], v[218:219] op_sel:[0,1,1] op_sel_hi:[1,1,1]
    v_pk_fma_f32 v[198:199], v[198:199], v[218:219], v[218:219] op_sel:[0,1,1] op_sel_hi:[1,1,1]
    v_rcp_f32 v192, v192
    v_rcp_f32 v193, v193
    v_rcp_f32 v194, v194
    v_rcp_f32 v195, v195
    v_rcp_f32 v196, v196
    v_rcp_f32 v197, v197
    v_rcp_f32 v198, v198
    v_rcp_f32 v199, v199
    v_pk_mul_f32 v[32:33], v[32:33], v[192:193]
    v_pk_mul_f32 v[34:35], v[34:35], v[194:195]
    v_pk_mul_f32 v[36:37], v[36:37], v[196:197]
    v_pk_mul_f32 v[38:39], v[38:39], v[198:199]
    v_cvt_pk_bf16_f32 v40, v32, v33
    v_cvt_pk_bf16_f32 v41, v34, v35
    v_cvt_pk_bf16_f32 v42, v36, v37
    v_cvt_pk_bf16_f32 v43, v38, v39
    s_add_u32 s91, s90, 46080
    buffer_store_dwordx4 v[40:43], v10, s[48:51], s91 offen sc1
    s_lshr_b32 s73, s68, 3
    s_xor_b32 s73, s73, 1
    s_mul_i32 s92, s73, 98304
    s_lshl_b32 s73, s73, 12
    s_add_u32 s93, s73, s85
    s_add_u32 m0, s93, 0
    s_add_u32 s73, s92, 0
    buffer_load_dwordx4 v252, s[52:55], s73 offen lds
    s_add_u32 m0, s93, 16384
    s_add_u32 s73, s92, 393216
    buffer_load_dwordx4 v252, s[52:55], s73 offen lds
    v_pk_mul_f32 v[192:193], v[48:49], s[96:97]
    v_pk_mul_f32 v[194:195], v[50:51], s[96:97]
    v_pk_mul_f32 v[196:197], v[52:53], s[96:97]
    v_pk_mul_f32 v[198:199], v[54:55], s[96:97]
    v_exp_f32 v192, v192
    v_exp_f32 v193, v193
    v_exp_f32 v194, v194
    v_exp_f32 v195, v195
    v_exp_f32 v196, v196
    v_exp_f32 v197, v197
    v_exp_f32 v198, v198
    v_exp_f32 v199, v199
    v_pk_mul_f32 v[48:49], v[48:49], v[56:57]
    v_pk_mul_f32 v[50:51], v[50:51], v[58:59]
    v_pk_mul_f32 v[52:53], v[52:53], v[60:61]
    v_pk_mul_f32 v[54:55], v[54:55], v[62:63]
    v_pk_fma_f32 v[192:193], v[192:193], v[218:219], v[218:219] op_sel:[0,0,0] op_sel_hi:[1,0,0]
    v_pk_fma_f32 v[194:195], v[194:195], v[218:219], v[218:219] op_sel:[0,0,0] op_sel_hi:[1,0,0]
    v_pk_fma_f32 v[196:197], v[196:197], v[218:219], v[218:219] op_sel:[0,0,0] op_sel_hi:[1,0,0]
    v_pk_fma_f32 v[198:199], v[198:199], v[218:219], v[218:219] op_sel:[0,0,0] op_sel_hi:[1,0,0]
    v_rcp_f32 v192, v192
    v_rcp_f32 v193, v193
    v_rcp_f32 v194, v194
    v_rcp_f32 v195, v195
    v_rcp_f32 v196, v196
    v_rcp_f32 v197, v197
    v_rcp_f32 v198, v198
    v_rcp_f32 v199, v199
    v_pk_mul_f32 v[48:49], v[48:49], v[192:193]
    v_pk_mul_f32 v[50:51], v[50:51], v[194:195]
    v_pk_mul_f32 v[52:53], v[52:53], v[196:197]
    v_pk_mul_f32 v[54:55], v[54:55], v[198:199]
    v_cvt_pk_bf16_f32 v56, v48, v49
    v_cvt_pk_bf16_f32 v57, v50, v51
    v_cvt_pk_bf16_f32 v58, v52, v53
    v_cvt_pk_bf16_f32 v59, v54, v55
    s_add_u32 s91, s90, 15360
    buffer_store_dwordx4 v[56:59], v10, s[48:51], s91 offen sc1
    s_lshr_b32 s73, s68, 3
    s_xor_b32 s73, s73, 2
    s_mul_i32 s92, s73, 98304
    s_lshl_b32 s73, s73, 12
    s_add_u32 s93, s73, s85
    s_add_u32 m0, s93, 0
    s_add_u32 s73, s92, 0
    buffer_load_dwordx4 v252, s[52:55], s73 offen lds
    s_add_u32 m0, s93, 16384
    s_add_u32 s73, s92, 393216
    buffer_load_dwordx4 v252, s[52:55], s73 offen lds
    v_pk_mul_f32 v[192:193], v[64:65], s[96:97]
    v_pk_mul_f32 v[194:195], v[66:67], s[96:97]
    v_pk_mul_f32 v[196:197], v[68:69], s[96:97]
    v_pk_mul_f32 v[198:199], v[70:71], s[96:97]
    v_exp_f32 v192, v192
    v_exp_f32 v193, v193
    v_exp_f32 v194, v194
    v_exp_f32 v195, v195
    v_exp_f32 v196, v196
    v_exp_f32 v197, v197
    v_exp_f32 v198, v198
    v_exp_f32 v199, v199
    v_pk_mul_f32 v[64:65], v[64:65], v[72:73]
    v_pk_mul_f32 v[66:67], v[66:67], v[74:75]
    v_pk_mul_f32 v[68:69], v[68:69], v[76:77]
    v_pk_mul_f32 v[70:71], v[70:71], v[78:79]
    v_pk_fma_f32 v[192:193], v[192:193], v[218:219], v[218:219] op_sel:[0,1,1] op_sel_hi:[1,1,1]
    v_pk_fma_f32 v[194:195], v[194:195], v[218:219], v[218:219] op_sel:[0,1,1] op_sel_hi:[1,1,1]
    v_pk_fma_f32 v[196:197], v[196:197], v[218:219], v[218:219] op_sel:[0,1,1] op_sel_hi:[1,1,1]
    v_pk_fma_f32 v[198:199], v[198:199], v[218:219], v[218:219] op_sel:[0,1,1] op_sel_hi:[1,1,1]
    v_rcp_f32 v192, v192
    v_rcp_f32 v193, v193
    s_waitcnt vmcnt(5)
    s_mov_b64 exec, 1
    buffer_store_dword v230, off, s[44:47], s82 offset:128
    s_mov_b64 exec, -1
    v_rcp_f32 v194, v194
    v_rcp_f32 v195, v195
    v_rcp_f32 v196, v196
    v_rcp_f32 v197, v197
    v_rcp_f32 v198, v198
    v_rcp_f32 v199, v199
    v_pk_mul_f32 v[64:65], v[64:65], v[192:193]
    v_pk_mul_f32 v[66:67], v[66:67], v[194:195]
    v_pk_mul_f32 v[68:69], v[68:69], v[196:197]
    v_pk_mul_f32 v[70:71], v[70:71], v[198:199]
    v_cvt_pk_bf16_f32 v72, v64, v65
    v_cvt_pk_bf16_f32 v73, v66, v67
    v_cvt_pk_bf16_f32 v74, v68, v69
    v_cvt_pk_bf16_f32 v75, v70, v71
    s_add_u32 s91, s90, 61440
    buffer_store_dwordx4 v[72:75], v10, s[48:51], s91 offen sc1
    s_lshr_b32 s73, s68, 3
    s_xor_b32 s73, s73, 3
    s_mul_i32 s92, s73, 98304
    s_lshl_b32 s73, s73, 12
    s_add_u32 s93, s73, s85
    s_add_u32 m0, s93, 0
    s_add_u32 s73, s92, 0
    buffer_load_dwordx4 v252, s[52:55], s73 offen lds
    s_add_u32 m0, s93, 16384
    s_add_u32 s73, s92, 393216
    buffer_load_dwordx4 v252, s[52:55], s73 offen lds
    v_pk_mul_f32 v[192:193], v[80:81], s[96:97]
    v_pk_mul_f32 v[194:195], v[82:83], s[96:97]
    v_pk_mul_f32 v[196:197], v[84:85], s[96:97]
    v_pk_mul_f32 v[198:199], v[86:87], s[96:97]
    v_exp_f32 v192, v192
    v_exp_f32 v193, v193
    v_exp_f32 v194, v194
    v_exp_f32 v195, v195
    v_exp_f32 v196, v196
    v_exp_f32 v197, v197
    v_exp_f32 v198, v198
    v_exp_f32 v199, v199
    v_pk_mul_f32 v[80:81], v[80:81], v[88:89]
    v_pk_mul_f32 v[82:83], v[82:83], v[90:91]
    v_pk_mul_f32 v[84:85], v[84:85], v[92:93]
    v_pk_mul_f32 v[86:87], v[86:87], v[94:95]
    v_pk_fma_f32 v[192:193], v[192:193], v[218:219], v[218:219] op_sel:[0,0,0] op_sel_hi:[1,0,0]
    v_pk_fma_f32 v[194:195], v[194:195], v[218:219], v[218:219] op_sel:[0,0,0] op_sel_hi:[1,0,0]
    v_pk_fma_f32 v[196:197], v[196:197], v[218:219], v[218:219] op_sel:[0,0,0] op_sel_hi:[1,0,0]
    v_pk_fma_f32 v[198:199], v[198:199], v[218:219], v[218:219] op_sel:[0,0,0] op_sel_hi:[1,0,0]
    v_rcp_f32 v192, v192
    v_rcp_f32 v193, v193
    v_rcp_f32 v194, v194
    v_rcp_f32 v195, v195
    v_rcp_f32 v196, v196
    v_rcp_f32 v197, v197
    v_rcp_f32 v198, v198
    v_rcp_f32 v199, v199
    v_pk_mul_f32 v[80:81], v[80:81], v[192:193]
    v_pk_mul_f32 v[82:83], v[82:83], v[194:195]
    v_pk_mul_f32 v[84:85], v[84:85], v[196:197]
    v_pk_mul_f32 v[86:87], v[86:87], v[198:199]
    v_cvt_pk_bf16_f32 v88, v80, v81
    v_cvt_pk_bf16_f32 v89, v82, v83
    v_cvt_pk_bf16_f32 v90, v84, v85
    v_cvt_pk_bf16_f32 v91, v86, v87
    v_pk_mul_f32 v[192:193], v[96:97], s[96:97]
    v_pk_mul_f32 v[194:195], v[98:99], s[96:97]
    v_pk_mul_f32 v[196:197], v[100:101], s[96:97]
    v_pk_mul_f32 v[198:199], v[102:103], s[96:97]
    v_exp_f32 v192, v192
    v_exp_f32 v193, v193
    v_exp_f32 v194, v194
    v_exp_f32 v195, v195
    v_exp_f32 v196, v196
    v_exp_f32 v197, v197
    v_exp_f32 v198, v198
    v_exp_f32 v199, v199
    v_pk_mul_f32 v[96:97], v[96:97], v[104:105]
    v_pk_mul_f32 v[98:99], v[98:99], v[106:107]
    v_pk_mul_f32 v[100:101], v[100:101], v[108:109]
    v_pk_mul_f32 v[102:103], v[102:103], v[110:111]
    v_pk_fma_f32 v[192:193], v[192:193], v[218:219], v[218:219] op_sel:[0,1,1] op_sel_hi:[1,1,1]
    v_pk_fma_f32 v[194:195], v[194:195], v[218:219], v[218:219] op_sel:[0,1,1] op_sel_hi:[1,1,1]
    v_pk_fma_f32 v[196:197], v[196:197], v[218:219], v[218:219] op_sel:[0,1,1] op_sel_hi:[1,1,1]
    v_pk_fma_f32 v[198:199], v[198:199], v[218:219], v[218:219] op_sel:[0,1,1] op_sel_hi:[1,1,1]
    v_rcp_f32 v192, v192
    v_rcp_f32 v193, v193
    v_rcp_f32 v194, v194
    v_rcp_f32 v195, v195
    v_rcp_f32 v196, v196
    v_rcp_f32 v197, v197
    v_rcp_f32 v198, v198
    v_rcp_f32 v199, v199
    v_pk_mul_f32 v[96:97], v[96:97], v[192:193]
    v_pk_mul_f32 v[98:99], v[98:99], v[194:195]
    v_pk_mul_f32 v[100:101], v[100:101], v[196:197]
    v_pk_mul_f32 v[102:103], v[102:103], v[198:199]
    v_cvt_pk_bf16_f32 v104, v96, v97
    v_cvt_pk_bf16_f32 v105, v98, v99
    v_cvt_pk_bf16_f32 v106, v100, v101
    v_cvt_pk_bf16_f32 v107, v102, v103
    buffer_load_dword v201, v216, s[44:47], 0 offen offset:128 sc1
    s_add_u32 s91, s90, 30720
    buffer_store_dwordx4 v[88:91], v10, s[48:51], s91 offen sc1
    s_add_u32 s91, s90, 76800
    buffer_store_dwordx4 v[104:107], v10, s[48:51], s91 offen sc1
    s_cmp_eq_u32 s87, 0
    s_cbranch_scc1 L_hfar
    s_waitcnt vmcnt(2)
    v_cmp_ne_u32 vcc, s30, v201
    s_cbranch_vccnz L_hretry
L_hgot:
    ds_write_b16 v229, v241 offset:32512
    s_setprio 0
    buffer_load_dwordx4 v[72:75], v10, s[64:67], 0 offen offset:0 sc1
    buffer_load_dwordx4 v[76:79], v10, s[64:67], 0 offen offset:1024 sc1
    s_add_u32 m0, s85, 32768
    s_mov_b32 s84, 786432
    buffer_load_dwordx4 v[80:83], v10, s[64:67], 0 offen offset:2048 sc1
    buffer_load_dwordx4 v252, s[52:55], s84 offen lds
    s_add_u32 m0, s85, 36864
    buffer_load_dwordx4 v[84:87], v10, s[64:67], 0 offen offset:3072 sc1
    buffer_load_dwordx4 v253, s[52:55], s84 offen lds
    s_add_u32 m0, s85, 40960
    s_mov_b32 s86, 4096
    buffer_load_dwordx4 v[88:91], v10, s[64:67], s86 offen offset:0 sc1
    buffer_load_dwordx4 v254, s[52:55], s84 offen lds
    s_add_u32 m0, s85, 45056
    buffer_load_dwordx4 v[92:95], v10, s[64:67], s86 offen offset:1024 sc1
    buffer_load_dwordx4 v255, s[52:55], s84 offen lds
    s_add_u32 m0, s85, 49152
    s_mov_b32 s84, 1179648
    buffer_load_dwordx4 v[96:99], v10, s[64:67], s86 offen offset:2048 sc1
    buffer_load_dwordx4 v252, s[52:55], s84 offen lds
    s_add_u32 m0, s85, 53248
    buffer_load_dwordx4 v[100:103], v10, s[64:67], s86 offen offset:3072 sc1
    buffer_load_dwordx4 v253, s[52:55], s84 offen lds
    s_setprio 2
    s_mov_b32 s31, 200000
L_lw_14:
    ds_read_b32 v12, v2 offset:32512
    s_waitcnt lgkmcnt(0)
    v_cmp_gt_i32 vcc, 3, v12
    s_cbranch_vccz L_ok_15
    s_sleep 1
    s_sub_u32 s31, s31, 1
    s_cmp_lg_u32 s31, 0
    s_cbranch_scc1 L_lw_14
L_ok_15:
    s_setprio 0
    ds_read_b64_tr_b16 v[48:49], v6 offset:0
    ds_read_b64_tr_b16 v[50:51], v6 offset:1024
    ds_read_b64_tr_b16 v[52:53], v7 offset:0
    ds_read_b64_tr_b16 v[54:55], v7 offset:1024
    ds_read_b64_tr_b16 v[56:57], v6 offset:4096
    ds_read_b64_tr_b16 v[58:59], v6 offset:5120
    ds_read_b64_tr_b16 v[60:61], v7 offset:4096
    ds_read_b64_tr_b16 v[62:63], v7 offset:5120
    s_waitcnt vmcnt(13) lgkmcnt(4)
    v_mfma_f32_32x32x16_bf16 v[16:31], v[48:51], v[72:75], 0
    v_mfma_f32_32x32x16_bf16 v[32:47], v[52:55], v[72:75], 0
    s_mov_b64 exec, 1
    buffer_store_dword v230, off, s[44:47], s82 offset:0
    buffer_store_dword v230, off, s[44:47], s95 sc1
    s_or_b32 s73, s2, s71
    s_cselect_b32 s42, 0, 4
    buffer_store_dword v230, off, s[40:43], 0 sc1
    s_mov_b64 exec, -1
    ds_read_b64_tr_b16 v[64:65], v6 offset:8192
    ds_read_b64_tr_b16 v[66:67], v6 offset:9216
    ds_read_b64_tr_b16 v[68:69], v7 offset:8192
    ds_read_b64_tr_b16 v[70:71], v7 offset:9216
    s_add_u32 m0, s85, 57344
    s_mov_b32 s86, 8192
    buffer_load_dwordx4 v[72:75], v10, s[64:67], s86 offen offset:0 sc1
    buffer_load_dwordx4 v254, s[52:55], s84 offen lds
    s_waitcnt vmcnt(17) lgkmcnt(4)
    v_mfma_f32_32x32x16_bf16 v[16:31], v[56:59], v[76:79], v[16:31]
    v_mfma_f32_32x32x16_bf16 v[32:47], v[60:63], v[76:79], v[32:47]
    ds_read_b64_tr_b16 v[48:49], v6 offset:12288
    ds_read_b64_tr_b16 v[50:51], v6 offset:13312
    ds_read_b64_tr_b16 v[52:53], v7 offset:12288
    ds_read_b64_tr_b16 v[54:55], v7 offset:13312
    s_add_u32 m0, s85, 61440
    s_mov_b32 s84, 16384
    buffer_load_dwordx4 v[76:79], v10, s[64:67], s86 offen offset:1024 sc1
    buffer_load_dwordx4 v252, s[52:55], s84 offen lds
    s_waitcnt vmcnt(18) lgkmcnt(4)
    v_mfma_f32_32x32x16_bf16 v[16:31], v[64:67], v[80:83], v[16:31]
    v_mfma_f32_32x32x16_bf16 v[32:47], v[68:71], v[80:83], v[32:47]
    ds_read_b64_tr_b16 v[56:57], v6 offset:16384
    ds_read_b64_tr_b16 v[58:59], v6 offset:17408
    ds_read_b64_tr_b16 v[60:61], v7 offset:16384
    ds_read_b64_tr_b16 v[62:63], v7 offset:17408
    s_add_u32 m0, s85, 65536
    buffer_load_dwordx4 v[80:83], v10, s[64:67], s86 offen offset:2048 sc1
    buffer_load_dwordx4 v253, s[52:55], s84 offen lds
    s_waitcnt vmcnt(18) lgkmcnt(4)
    v_mfma_f32_32x32x16_bf16 v[16:31], v[48:51], v[84:87], v[16:31]
    v_mfma_f32_32x32x16_bf16 v[32:47], v[52:55], v[84:87], v[32:47]
    ds_read_b64_tr_b16 v[64:65], v6 offset:20480
    ds_read_b64_tr_b16 v[66:67], v6 offset:21504
    ds_read_b64_tr_b16 v[68:69], v7 offset:20480
    ds_read_b64_tr_b16 v[70:71], v7 offset:21504
    s_add_u32 m0, s85, 69632
    buffer_load_dwordx4 v[84:87], v10, s[64:67], s86 offen offset:3072 sc1
    buffer_load_dwordx4 v254, s[52:55], s84 offen lds
    s_add_u32 m0, s85, 73728
    s_nop 0
    buffer_load_dwordx4 v255, s[52:55], s84 offen lds
    s_waitcnt vmcnt(19) lgkmcnt(4)
    v_mfma_f32_32x32x16_bf16 v[16:31], v[56:59], v[88:91], v[16:31]
    v_mfma_f32_32x32x16_bf16 v[32:47], v[60:63], v[88:91], v[32:47]
    ds_read_b64_tr_b16 v[48:49], v6 offset:24576
    ds_read_b64_tr_b16 v[50:51], v6 offset:25600
    ds_read_b64_tr_b16 v[52:53], v7 offset:24576
    ds_read_b64_tr_b16 v[54:55], v7 offset:25600
    s_waitcnt vmcnt(14)
    ds_write_b16_d16_hi v229, v241 offset:32512
    s_add_u32 m0, s85, 77824
    s_mov_b32 s84, 409600
    s_mov_b32 s86, 12288
    buffer_load_dwordx4 v[88:91], v10, s[64:67], s86 offen offset:0 sc1
    buffer_load_dwordx4 v252, s[52:55], s84 offen lds
    s_waitcnt lgkmcnt(5)
    v_mfma_f32_32x32x16_bf16 v[16:31], v[64:67], v[92:95], v[16:31]
    v_mfma_f32_32x32x16_bf16 v[32:47], v[68:71], v[92:95], v[32:47]
    buffer_load_dword v201, v232, s[44:47], 0 offen offset:0 sc1
    ds_read_b64_tr_b16 v[56:57], v6 offset:28672
    ds_read_b64_tr_b16 v[58:59], v6 offset:29696
    ds_read_b64_tr_b16 v[60:61], v7 offset:28672
    ds_read_b64_tr_b16 v[62:63], v7 offset:29696
    ds_read_b32 v12, v2 offset:32512
    s_add_u32 m0, s85, 81920
    buffer_load_dwordx4 v[92:95], v10, s[64:67], s86 offen offset:1024 sc1
    buffer_load_dwordx4 v253, s[52:55], s84 offen lds
    s_waitcnt lgkmcnt(6)
    v_mfma_f32_32x32x16_bf16 v[16:31], v[48:51], v[96:99], v[16:31]
    v_mfma_f32_32x32x16_bf16 v[32:47], v[52:55], v[96:99], v[32:47]
    s_setprio 2
    s_waitcnt lgkmcnt(0)
    v_cmp_gt_i32 vcc, 4, v12
    s_cbranch_vccnz L_cs_16
L_cg_17:
    s_setprio 0
    ds_read_b64_tr_b16 v[64:65], v6 offset:32768
    ds_read_b64_tr_b16 v[66:67], v6 offset:33792
    ds_read_b64_tr_b16 v[68:69], v7 offset:32768
    ds_read_b64_tr_b16 v[70:71], v7 offset:33792
    s_add_u32 m0, s85, 86016
    s_add_u32 s73, s86, s79
    buffer_load_dwordx4 v[96:99], v10, s[64:67], s73 offen offset:2048 sc1
    buffer_load_dwordx4 v254, s[52:55], s84 offen lds
    s_waitcnt vmcnt(20)
    v_mfma_f32_32x32x16_bf16 v[16:31], v[56:59], v[100:103], v[16:31]
    v_mfma_f32_32x32x16_bf16 v[32:47], v[60:63], v[100:103], v[32:47]
    ds_read_b64_tr_b16 v[48:49], v6 offset:36864
    ds_read_b64_tr_b16 v[50:51], v6 offset:37888
    ds_read_b64_tr_b16 v[52:53], v7 offset:36864
    ds_read_b64_tr_b16 v[54:55], v7 offset:37888
    s_add_u32 m0, s85, 90112
    s_nop 0
    buffer_load_dwordx4 v255, s[52:55], s84 offen lds
    s_add_u32 m0, s85, 94208
    s_mov_b32 s84, 802816
    buffer_load_dwordx4 v252, s[52:55], s84 offen lds
    s_waitcnt vmcnt(17) lgkmcnt(4)
    v_mfma_f32_32x32x16_bf16 v[16:31], v[64:67], v[72:75], v[16:31]
    v_mfma_f32_32x32x16_bf16 v[32:47], v[68:71], v[72:75], v[32:47]
    s_setprio 2
    s_waitcnt vmcnt(6)
    v_cmp_ne_u32 vcc, s30, v201
    s_cbranch_vccnz L_h2retry
L_h2got:
    s_setprio 0
    ds_read_b64_tr_b16 v[56:57], v6 offset:40960
    ds_read_b64_tr_b16 v[58:59], v6 offset:41984
    ds_read_b64_tr_b16 v[60:61], v7 offset:40960
    ds_read_b64_tr_b16 v[62:63], v7 offset:41984
    s_add_u32 m0, s85, 98304
    buffer_load_dwordx4 v[100:103], v10, s[64:67], s86 offen offset:3072 sc1
    buffer_load_dwordx4 v253, s[52:55], s84 offen lds
    s_mov_b32 s86, 16384
    buffer_load_dwordx4 v[72:75], v10, s[64:67], s86 offen offset:0 sc1
    s_waitcnt lgkmcnt(4)
    v_mfma_f32_32x32x16_bf16 v[16:31], v[48:51], v[76:79], v[16:31]
    v_mfma_f32_32x32x16_bf16 v[32:47], v[52:55], v[76:79], v[32:47]
    ds_read_b64_tr_b16 v[64:65], v6 offset:45056
    ds_read_b64_tr_b16 v[66:67], v6 offset:46080
    ds_read_b64_tr_b16 v[68:69], v7 offset:45056
    ds_read_b64_tr_b16 v[70:71], v7 offset:46080
    ds_write_b16 v229, v242 offset:32512
    s_add_u32 m0, s85, 102400
    buffer_load_dwordx4 v[76:79], v10, s[64:67], s86 offen offset:1024 sc1
    buffer_load_dwordx4 v254, s[52:55], s84 offen lds
    s_waitcnt lgkmcnt(5)
    v_mfma_f32_32x32x16_bf16 v[16:31], v[56:59], v[80:83], v[16:31]
    v_mfma_f32_32x32x16_bf16 v[32:47], v[60:63], v[80:83], v[32:47]
    ds_read_b64_tr_b16 v[48:49], v6 offset:49152
    ds_read_b64_tr_b16 v[50:51], v6 offset:50176
    ds_read_b64_tr_b16 v[52:53], v7 offset:49152
    ds_read_b64_tr_b16 v[54:55], v7 offset:50176
    ds_read_b32 v12, v2 offset:32512
    s_add_u32 m0, s85, 0
    buffer_load_dwordx4 v[80:83], v10, s[64:67], s86 offen offset:2048 sc1
    buffer_load_dwordx4 v255, s[52:55], s84 offen lds
    s_waitcnt lgkmcnt(6)
    v_mfma_f32_32x32x16_bf16 v[16:31], v[64:67], v[84:87], v[16:31]
    v_mfma_f32_32x32x16_bf16 v[32:47], v[68:71], v[84:87], v[32:47]
    s_setprio 2
    s_waitcnt lgkmcnt(0)
    v_cmp_gt_i32 vcc, 5, v12
    s_cbranch_vccnz L_cs_18
L_cg_19:
    s_setprio 0
    ds_read_b64_tr_b16 v[56:57], v6 offset:53248
    ds_read_b64_tr_b16 v[58:59], v6 offset:54272
    ds_read_b64_tr_b16 v[60:61], v7 offset:53248
    ds_read_b64_tr_b16 v[62:63], v7 offset:54272
    s_add_u32 m0, s85, 4096
    s_mov_b32 s84, 1196032
    buffer_load_dwordx4 v[84:87], v10, s[64:67], s86 offen offset:3072 sc1
    buffer_load_dwordx4 v252, s[52:55], s84 offen lds
    s_add_u32 m0, s85, 8192
    s_nop 0
    buffer_load_dwordx4 v253, s[52:55], s84 offen lds
    v_mfma_f32_32x32x16_bf16 v[16:31], v[48:51], v[88:91], v[16:31]
    v_mfma_f32_32x32x16_bf16 v[32:47], v[52:55], v[88:91], v[32:47]
    ds_read_b64_tr_b16 v[64:65], v6 offset:57344
    ds_read_b64_tr_b16 v[66:67], v6 offset:58368
    ds_read_b64_tr_b16 v[68:69], v7 offset:57344
    ds_read_b64_tr_b16 v[70:71], v7 offset:58368
    s_add_u32 m0, s85, 12288
    s_mov_b32 s86, 20480
    buffer_load_dwordx4 v[88:91], v10, s[64:67], s86 offen offset:0 sc1
    buffer_load_dwordx4 v254, s[52:55], s84 offen lds
    s_waitcnt vmcnt(17) lgkmcnt(4)
    v_mfma_f32_32x32x16_bf16 v[16:31], v[56:59], v[92:95], v[16:31]
    v_mfma_f32_32x32x16_bf16 v[32:47], v[60:63], v[92:95], v[32:47]
    ds_read_b64_tr_b16 v[48:49], v6 offset:61440
    ds_read_b64_tr_b16 v[50:51], v6 offset:62464
    ds_read_b64_tr_b16 v[52:53], v7 offset:61440
    ds_read_b64_tr_b16 v[54:55], v7 offset:62464
    s_add_u32 m0, s85, 16384
    s_mov_b32 s84, 32768
    buffer_load_dwordx4 v[92:95], v10, s[64:67], s86 offen offset:1024 sc1
    buffer_load_dwordx4 v252, s[52:55], s84 offen lds
    s_waitcnt vmcnt(17) lgkmcnt(4)
    v_mfma_f32_32x32x16_bf16 v[16:31], v[64:67], v[96:99], v[16:31]
    v_mfma_f32_32x32x16_bf16 v[32:47], v[68:71], v[96:99], v[32:47]
    ds_read_b64_tr_b16 v[56:57], v8 offset:0
    ds_read_b64_tr_b16 v[58:59], v8 offset:1024
    ds_read_b64_tr_b16 v[60:61], v9 offset:0
    ds_read_b64_tr_b16 v[62:63], v9 offset:1024
    s_waitcnt vmcnt(15)
    ds_write_b16_d16_hi v229, v242 offset:32512
    s_add_u32 m0, s85, 20480
    buffer_load_dwordx4 v[96:99], v10, s[64:67], s86 offen offset:2048 sc1
    buffer_load_dwordx4 v253, s[52:55], s84 offen lds
    s_waitcnt vmcnt(15) lgkmcnt(5)
    v_mfma_f32_32x32x16_bf16 v[16:31], v[48:51], v[100:103], v[16:31]
    v_mfma_f32_32x32x16_bf16 v[32:47], v[52:55], v[100:103], v[32:47]
    ds_read_b64_tr_b16 v[64:65], v8 offset:4096
    ds_read_b64_tr_b16 v[66:67], v8 offset:5120
    ds_read_b64_tr_b16 v[68:69], v9 offset:4096
    ds_read_b64_tr_b16 v[70:71], v9 offset:5120
    ds_read_b32 v12, v2 offset:32512
    s_add_u32 m0, s85, 24576
    buffer_load_dwordx4 v[100:103], v10, s[64:67], s86 offen offset:3072 sc1
    buffer_load_dwordx4 v254, s[52:55], s84 offen lds
    s_add_u32 m0, s85, 28672
    s_nop 0
    buffer_load_dwordx4 v255, s[52:55], s84 offen lds
    s_waitcnt vmcnt(16) lgkmcnt(6)
    v_mfma_f32_32x32x16_bf16 v[16:31], v[56:59], v[72:75], v[16:31]
    v_mfma_f32_32x32x16_bf16 v[32:47], v[60:63], v[72:75], v[32:47]
    s_setprio 2
    s_waitcnt lgkmcnt(0)
    v_cmp_gt_i32 vcc, 6, v12
    s_cbranch_vccnz L_cs_20
L_cg_21:
    s_setprio 0
    ds_read_b64_tr_b16 v[48:49], v8 offset:8192
    ds_read_b64_tr_b16 v[50:51], v8 offset:9216
    ds_read_b64_tr_b16 v[52:53], v9 offset:8192
    ds_read_b64_tr_b16 v[54:55], v9 offset:9216
    s_add_u32 m0, s85, 32768
    s_mov_b32 s84, 425984
    s_mov_b32 s86, 24576
    buffer_load_dwordx4 v[72:75], v10, s[64:67], s86 offen offset:0 sc1
    buffer_load_dwordx4 v252, s[52:55], s84 offen lds
    s_waitcnt vmcnt(17)
    v_mfma_f32_32x32x16_bf16 v[16:31], v[64:67], v[76:79], v[16:31]
    v_mfma_f32_32x32x16_bf16 v[32:47], v[68:71], v[76:79], v[32:47]
    ds_read_b64_tr_b16 v[56:57], v8 offset:12288
    ds_read_b64_tr_b16 v[58:59], v8 offset:13312
    ds_read_b64_tr_b16 v[60:61], v9 offset:12288
    ds_read_b64_tr_b16 v[62:63], v9 offset:13312
    s_add_u32 m0, s85, 36864
    buffer_load_dwordx4 v[76:79], v10, s[64:67], s86 offen offset:1024 sc1
    buffer_load_dwordx4 v253, s[52:55], s84 offen lds
    s_waitcnt vmcnt(17) lgkmcnt(4)
    v_mfma_f32_32x32x16_bf16 v[16:31], v[48:51], v[80:83], v[16:31]
    v_mfma_f32_32x32x16_bf16 v[32:47], v[52:55], v[80:83], v[32:47]
    ds_read_b64_tr_b16 v[64:65], v8 offset:16384
    ds_read_b64_tr_b16 v[66:67], v8 offset:17408
    ds_read_b64_tr_b16 v[68:69], v9 offset:16384
    ds_read_b64_tr_b16 v[70:71], v9 offset:17408
    s_add_u32 m0, s85, 40960
    buffer_load_dwordx4 v[80:83], v10, s[64:67], s86 offen offset:2048 sc1
    buffer_load_dwordx4 v254, s[52:55], s84 offen lds
    s_waitcnt vmcnt(17) lgkmcnt(4)
    v_mfma_f32_32x32x16_bf16 v[16:31], v[56:59], v[84:87], v[16:31]
    v_mfma_f32_32x32x16_bf16 v[32:47], v[60:63], v[84:87], v[32:47]
    ds_read_b64_tr_b16 v[48:49], v8 offset:20480
    ds_read_b64_tr_b16 v[50:51], v8 offset:21504
    ds_read_b64_tr_b16 v[52:53], v9 offset:20480
    ds_read_b64_tr_b16 v[54:55], v9 offset:21504
    s_waitcnt vmcnt(16)
    ds_write_b16 v229, v243 offset:32512
    s_add_u32 m0, s85, 45056
    buffer_load_dwordx4 v[84:87], v10, s[64:67], s86 offen offset:3072 sc1
    buffer_load_dwordx4 v255, s[52:55], s84 offen lds
    s_add_u32 m0, s85, 49152
    s_mov_b32 s84, 819200
    buffer_load_dwordx4 v252, s[52:55], s84 offen lds
    s_waitcnt vmcnt(17) lgkmcnt(5)
    v_mfma_f32_32x32x16_bf16 v[16:31], v[64:67], v[88:91], v[16:31]
    v_mfma_f32_32x32x16_bf16 v[32:47], v[68:71], v[88:91], v[32:47]
    ds_read_b64_tr_b16 v[56:57], v8 offset:24576
    ds_read_b64_tr_b16 v[58:59], v8 offset:25600
    ds_read_b64_tr_b16 v[60:61], v9 offset:24576
    ds_read_b64_tr_b16 v[62:63], v9 offset:25600
    ds_read_b32 v12, v2 offset:32512
    s_add_u32 m0, s85, 53248
    s_mov_b32 s86, 28672
    buffer_load_dwordx4 v[88:91], v10, s[64:67], s86 offen offset:0 sc1
    buffer_load_dwordx4 v253, s[52:55], s84 offen lds
    s_waitcnt vmcnt(17) lgkmcnt(6)
    v_mfma_f32_32x32x16_bf16 v[16:31], v[48:51], v[92:95], v[16:31]
    v_mfma_f32_32x32x16_bf16 v[32:47], v[52:55], v[92:95], v[32:47]
    s_setprio 2
    s_waitcnt lgkmcnt(0)
    v_cmp_gt_i32 vcc, 7, v12
    s_cbranch_vccnz L_cs_22
L_cg_23:
    s_setprio 0
    ds_read_b64_tr_b16 v[64:65], v8 offset:28672
    ds_read_b64_tr_b16 v[66:67], v8 offset:29696
    ds_read_b64_tr_b16 v[68:69], v9 offset:28672
    ds_read_b64_tr_b16 v[70:71], v9 offset:29696
    s_add_u32 m0, s85, 57344
    s_add_u32 s73, s86, s79
    buffer_load_dwordx4 v[92:95], v10, s[64:67], s73 offen offset:1024 sc1
    buffer_load_dwordx4 v254, s[52:55], s84 offen lds
    s_waitcnt vmcnt(17)
    v_mfma_f32_32x32x16_bf16 v[16:31], v[56:59], v[96:99], v[16:31]
    v_mfma_f32_32x32x16_bf16 v[32:47], v[60:63], v[96:99], v[32:47]
    ds_read_b64_tr_b16 v[48:49], v8 offset:32768
    ds_read_b64_tr_b16 v[50:51], v8 offset:33792
    ds_read_b64_tr_b16 v[52:53], v9 offset:32768
    ds_read_b64_tr_b16 v[54:55], v9 offset:33792
    s_add_u32 m0, s85, 61440
    buffer_load_dwordx4 v[96:99], v10, s[64:67], s86 offen offset:2048 sc1
    buffer_load_dwordx4 v255, s[52:55], s84 offen lds
    s_waitcnt vmcnt(17) lgkmcnt(4)
    v_mfma_f32_32x32x16_bf16 v[16:31], v[64:67], v[100:103], v[16:31]
    v_mfma_f32_32x32x16_bf16 v[32:47], v[68:71], v[100:103], v[32:47]
    ds_read_b64_tr_b16 v[56:57], v8 offset:36864
    ds_read_b64_tr_b16 v[58:59], v8 offset:37888
    ds_read_b64_tr_b16 v[60:61], v9 offset:36864
    ds_read_b64_tr_b16 v[62:63], v9 offset:37888
    s_add_u32 m0, s85, 65536
    s_mov_b32 s84, 1212416
    buffer_load_dwordx4 v[100:103], v10, s[64:67], s86 offen offset:3072 sc1
    buffer_load_dwordx4 v252, s[52:55], s84 offen lds
    s_add_u32 m0, s85, 69632
    s_nop 0
    buffer_load_dwordx4 v253, s[52:55], s84 offen lds
    s_waitcnt vmcnt(17) lgkmcnt(4)
    v_mfma_f32_32x32x16_bf16 v[16:31], v[48:51], v[72:75], v[16:31]
    v_mfma_f32_32x32x16_bf16 v[32:47], v[52:55], v[72:75], v[32:47]
    ds_read_b64_tr_b16 v[64:65], v6 offset:0
    ds_read_b64_tr_b16 v[66:67], v6 offset:1024
    ds_read_b64_tr_b16 v[68:69], v7 offset:0
    ds_read_b64_tr_b16 v[70:71], v7 offset:1024
    ds_write_b16_d16_hi v229, v243 offset:32512
    s_add_u32 m0, s85, 73728
    s_mov_b32 s84, 0
    s_mov_b32 s86, 32768
    buffer_load_dwordx4 v[72:75], v10, s[64:67], s86 offen offset:0 sc1
    buffer_load_dwordx4 v252, s[56:59], s84 offen lds
    s_waitcnt vmcnt(17) lgkmcnt(5)
    v_mfma_f32_32x32x16_bf16 v[16:31], v[56:59], v[76:79], v[16:31]
    v_mfma_f32_32x32x16_bf16 v[32:47], v[60:63], v[76:79], v[32:47]
    ds_read_b64_tr_b16 v[48:49], v6 offset:4096
    ds_read_b64_tr_b16 v[50:51], v6 offset:5120
    ds_read_b64_tr_b16 v[52:53], v7 offset:4096
    ds_read_b64_tr_b16 v[54:55], v7 offset:5120
    ds_read_b32 v12, v2 offset:32512
    s_add_u32 m0, s85, 77824
    s_mov_b32 s84, 65536
    buffer_load_dwordx4 v[76:79], v10, s[64:67], s86 offen offset:1024 sc1
    buffer_load_dwordx4 v252, s[56:59], s84 offen lds
    s_waitcnt vmcnt(17) lgkmcnt(6)
    v_mfma_f32_32x32x16_bf16 v[16:31], v[64:67], v[80:83], v[16:31]
    v_mfma_f32_32x32x16_bf16 v[32:47], v[68:71], v[80:83], v[32:47]
    s_setprio 2
    s_waitcnt lgkmcnt(0)
    v_cmp_gt_i32 vcc, 8, v12
    s_cbranch_vccnz L_cs_24
L_cg_25:
    s_setprio 0
    ds_read_b64_tr_b16 v[56:57], v6 offset:8192
    ds_read_b64_tr_b16 v[58:59], v6 offset:9216
    ds_read_b64_tr_b16 v[60:61], v7 offset:8192
    ds_read_b64_tr_b16 v[62:63], v7 offset:9216
    s_add_u32 m0, s85, 81920
    s_mov_b32 s84, 131072
    buffer_load_dwordx4 v[80:83], v10, s[64:67], s86 offen offset:2048 sc1
    buffer_load_dwordx4 v252, s[56:59], s84 offen lds
    s_waitcnt vmcnt(17)
    v_mfma_f32_32x32x16_bf16 v[16:31], v[48:51], v[84:87], v[16:31]
    v_mfma_f32_32x32x16_bf16 v[32:47], v[52:55], v[84:87], v[32:47]
    ds_read_b64_tr_b16 v[64:65], v6 offset:12288
    ds_read_b64_tr_b16 v[66:67], v6 offset:13312
    ds_read_b64_tr_b16 v[68:69], v7 offset:12288
    ds_read_b64_tr_b16 v[70:71], v7 offset:13312
    s_add_u32 m0, s85, 86016
    s_mov_b32 s84, 196608
    buffer_load_dwordx4 v[84:87], v10, s[64:67], s86 offen offset:3072 sc1
    buffer_load_dwordx4 v252, s[56:59], s84 offen lds
    s_add_u32 m0, s85, 90112
    s_mov_b32 s84, 262144
    buffer_load_dwordx4 v252, s[56:59], s84 offen lds
    s_waitcnt vmcnt(17) lgkmcnt(4)
    v_mfma_f32_32x32x16_bf16 v[16:31], v[56:59], v[88:91], v[16:31]
    v_mfma_f32_32x32x16_bf16 v[32:47], v[60:63], v[88:91], v[32:47]
    ds_read_b64_tr_b16 v[48:49], v6 offset:16384
    ds_read_b64_tr_b16 v[50:51], v6 offset:17408
    ds_read_b64_tr_b16 v[52:53], v7 offset:16384
    ds_read_b64_tr_b16 v[54:55], v7 offset:17408
    s_add_u32 m0, s85, 94208
    s_mov_b32 s84, 327680
    s_mov_b32 s86, 36864
    buffer_load_dwordx4 v[88:91], v10, s[64:67], s86 offen offset:0 sc1
    buffer_load_dwordx4 v252, s[56:59], s84 offen lds
    s_waitcnt vmcnt(17) lgkmcnt(4)
    v_mfma_f32_32x32x16_bf16 v[16:31], v[64:67], v[92:95], v[16:31]
    v_mfma_f32_32x32x16_bf16 v[32:47], v[68:71], v[92:95], v[32:47]
    ds_read_b64_tr_b16 v[56:57], v6 offset:20480
    ds_read_b64_tr_b16 v[58:59], v6 offset:21504
    ds_read_b64_tr_b16 v[60:61], v7 offset:20480
    ds_read_b64_tr_b16 v[62:63], v7 offset:21504
    ds_write_b16 v229, v244 offset:32512
    s_add_u32 m0, s85, 98304
    s_mov_b32 s84, 393216
    buffer_load_dwordx4 v[92:95], v10, s[64:67], s86 offen offset:1024 sc1
    buffer_load_dwordx4 v252, s[56:59], s84 offen lds
    s_waitcnt vmcnt(17) lgkmcnt(5)
    v_mfma_f32_32x32x16_bf16 v[16:31], v[48:51], v[96:99], v[16:31]
    v_mfma_f32_32x32x16_bf16 v[32:47], v[52:55], v[96:99], v[32:47]
    ds_read_b64_tr_b16 v[64:65], v6 offset:24576
    ds_read_b64_tr_b16 v[66:67], v6 offset:25600
    ds_read_b64_tr_b16 v[68:69], v7 offset:24576
    ds_read_b64_tr_b16 v[70:71], v7 offset:25600
    ds_read_b32 v12, v2 offset:32512
    s_add_u32 m0, s85, 102400
    s_mov_b32 s84, 458752
    buffer_load_dwordx4 v[96:99], v10, s[64:67], s86 offen offset:2048 sc1
    buffer_load_dwordx4 v252, s[56:59], s84 offen lds
    s_waitcnt vmcnt(17) lgkmcnt(6)
    v_mfma_f32_32x32x16_bf16 v[16:31], v[56:59], v[100:103], v[16:31]
    v_mfma_f32_32x32x16_bf16 v[32:47], v[60:63], v[100:103], v[32:47]
    s_setprio 2
    s_waitcnt lgkmcnt(0)
    v_cmp_gt_i32 vcc, 9, v12
    s_cbranch_vccnz L_cs_26
L_cg_27:
    s_setprio 0
    ds_read_b64_tr_b16 v[48:49], v6 offset:28672
    ds_read_b64_tr_b16 v[50:51], v6 offset:29696
    ds_read_b64_tr_b16 v[52:53], v7 offset:28672
    ds_read_b64_tr_b16 v[54:55], v7 offset:29696
    s_add_u32 m0, s85, 0
    s_mov_b32 s84, 16384
    buffer_load_dwordx4 v[100:103], v10, s[64:67], s86 offen offset:3072 sc1
    buffer_load_dwordx4 v252, s[56:59], s84 offen lds
    s_add_u32 m0, s85, 4096
    s_mov_b32 s84, 81920
    buffer_load_dwordx4 v252, s[56:59], s84 offen lds
    s_waitcnt vmcnt(17)
    v_mfma_f32_32x32x16_bf16 v[16:31], v[64:67], v[72:75], v[16:31]
    v_mfma_f32_32x32x16_bf16 v[32:47], v[68:71], v[72:75], v[32:47]
    ds_read_b64_tr_b16 v[56:57], v6 offset:32768
    ds_read_b64_tr_b16 v[58:59], v6 offset:33792
    ds_read_b64_tr_b16 v[60:61], v7 offset:32768
    ds_read_b64_tr_b16 v[62:63], v7 offset:33792
    s_waitcnt vmcnt(16)
    ds_write_b16_d16_hi v229, v244 offset:32512
    s_add_u32 m0, s85, 8192
    s_mov_b32 s84, 147456
    s_mov_b32 s86, 40960
    buffer_load_dwordx4 v[72:75], v10, s[64:67], s86 offen offset:0 sc1
    buffer_load_dwordx4 v252, s[56:59], s84 offen lds
    s_waitcnt vmcnt(17) lgkmcnt(5)
    v_mfma_f32_32x32x16_bf16 v[16:31], v[48:51], v[76:79], v[16:31]
    v_mfma_f32_32x32x16_bf16 v[32:47], v[52:55], v[76:79], v[32:47]
    ds_read_b64_tr_b16 v[64:65], v6 offset:36864
    ds_read_b64_tr_b16 v[66:67], v6 offset:37888
    ds_read_b64_tr_b16 v[68:69], v7 offset:36864
    ds_read_b64_tr_b16 v[70:71], v7 offset:37888
    ds_read_b32 v12, v2 offset:32512
    s_add_u32 m0, s85, 12288
    s_mov_b32 s84, 212992
    buffer_load_dwordx4 v[76:79], v10, s[64:67], s86 offen offset:1024 sc1
    buffer_load_dwordx4 v252, s[56:59], s84 offen lds
    s_waitcnt vmcnt(17) lgkmcnt(6)
    v_mfma_f32_32x32x16_bf16 v[16:31], v[56:59], v[80:83], v[16:31]
    v_mfma_f32_32x32x16_bf16 v[32:47], v[60:63], v[80:83], v[32:47]
    s_setprio 2
    s_waitcnt lgkmcnt(0)
    v_cmp_gt_i32 vcc, 10, v12
    s_cbranch_vccnz L_cs_28
L_cg_29:
    s_setprio 0
    ds_read_b64_tr_b16 v[48:49], v6 offset:40960
    ds_read_b64_tr_b16 v[50:51], v6 offset:41984
    ds_read_b64_tr_b16 v[52:53], v7 offset:40960
    ds_read_b64_tr_b16 v[54:55], v7 offset:41984
    s_add_u32 m0, s85, 16384
    s_mov_b32 s84, 278528
    buffer_load_dwordx4 v[80:83], v10, s[64:67], s86 offen offset:2048 sc1
    buffer_load_dwordx4 v252, s[56:59], s84 offen lds
    s_waitcnt vmcnt(17)
    v_mfma_f32_32x32x16_bf16 v[16:31], v[64:67], v[84:87], v[16:31]
    v_mfma_f32_32x32x16_bf16 v[32:47], v[68:71], v[84:87], v[32:47]
    ds_read_b64_tr_b16 v[56:57], v6 offset:45056
    ds_read_b64_tr_b16 v[58:59], v6 offset:46080
    ds_read_b64_tr_b16 v[60:61], v7 offset:45056
    ds_read_b64_tr_b16 v[62:63], v7 offset:46080
    s_add_u32 m0, s85, 20480
    s_mov_b32 s84, 344064
    buffer_load_dwordx4 v[84:87], v10, s[64:67], s86 offen offset:3072 sc1
    buffer_load_dwordx4 v252, s[56:59], s84 offen lds
    s_add_u32 m0, s85, 24576
    s_mov_b32 s84, 409600
    buffer_load_dwordx4 v252, s[56:59], s84 offen lds
    s_waitcnt vmcnt(17) lgkmcnt(4)
    v_mfma_f32_32x32x16_bf16 v[16:31], v[48:51], v[88:91], v[16:31]
    v_mfma_f32_32x32x16_bf16 v[32:47], v[52:55], v[88:91], v[32:47]
    ds_read_b64_tr_b16 v[64:65], v6 offset:49152
    ds_read_b64_tr_b16 v[66:67], v6 offset:50176
    ds_read_b64_tr_b16 v[68:69], v7 offset:49152
    ds_read_b64_tr_b16 v[70:71], v7 offset:50176
    s_add_u32 m0, s85, 28672
    s_mov_b32 s84, 475136
    buffer_load_dwordx4 v252, s[56:59], s84 offen lds
    s_waitcnt vmcnt(16) lgkmcnt(4)
    v_mfma_f32_32x32x16_bf16 v[16:31], v[56:59], v[92:95], v[16:31]
    v_mfma_f32_32x32x16_bf16 v[32:47], v[60:63], v[92:95], v[32:47]
    ds_read_b64_tr_b16 v[48:49], v6 offset:53248
    ds_read_b64_tr_b16 v[50:51], v6 offset:54272
    ds_read_b64_tr_b16 v[52:53], v7 offset:53248
    ds_read_b64_tr_b16 v[54:55], v7 offset:54272
    s_waitcnt vmcnt(14) lgkmcnt(4)
    v_mfma_f32_32x32x16_bf16 v[16:31], v[64:67], v[96:99], v[16:31]
    v_mfma_f32_32x32x16_bf16 v[32:47], v[68:71], v[96:99], v[32:47]
    ds_read_b64_tr_b16 v[56:57], v6 offset:57344
    ds_read_b64_tr_b16 v[58:59], v6 offset:58368
    ds_read_b64_tr_b16 v[60:61], v7 offset:57344
    ds_read_b64_tr_b16 v[62:63], v7 offset:58368
    buffer_load_dwordx4 v[104:107], v10, s[44:47], s36 offen offset:0 sc1
    buffer_load_dwordx4 v[108:111], v10, s[44:47], s36 offen offset:2048 sc1
    buffer_load_dwordx4 v[112:115], v10, s[44:47], s37 offen offset:0 sc1
    s_waitcnt vmcnt(15) lgkmcnt(4)
    v_mfma_f32_32x32x16_bf16 v[16:31], v[48:51], v[100:103], v[16:31]
    v_mfma_f32_32x32x16_bf16 v[32:47], v[52:55], v[100:103], v[32:47]
    ds_read_b64_tr_b16 v[64:65], v6 offset:61440
    ds_read_b64_tr_b16 v[66:67], v6 offset:62464
    ds_read_b64_tr_b16 v[68:69], v7 offset:61440
    ds_read_b64_tr_b16 v[70:71], v7 offset:62464
    buffer_load_dwordx4 v[116:119], v10, s[44:47], s37 offen offset:2048 sc1
    buffer_load_dwordx4 v[120:123], v10, s[44:47], s38 offen offset:0 sc1
    buffer_load_dwordx4 v[124:127], v10, s[44:47], s38 offen offset:2048 sc1
    s_waitcnt vmcnt(15) lgkmcnt(4)
    v_mfma_f32_32x32x16_bf16 v[16:31], v[56:59], v[72:75], v[16:31]
    v_mfma_f32_32x32x16_bf16 v[32:47], v[60:63], v[72:75], v[32:47]
    ds_read_b64_tr_b16 v[48:49], v8 offset:0
    ds_read_b64_tr_b16 v[50:51], v8 offset:1024
    ds_read_b64_tr_b16 v[52:53], v9 offset:0
    ds_read_b64_tr_b16 v[54:55], v9 offset:1024
    s_waitcnt vmcnt(6)
    ds_write_b16 v229, v245 offset:32512
    buffer_load_dwordx4 v[128:131], v10, s[44:47], s39 offen offset:0 sc1
    buffer_load_dwordx4 v[132:135], v10, s[44:47], s39 offen offset:2048 sc1
    s_waitcnt lgkmcnt(5)
    v_mfma_f32_32x32x16_bf16 v[16:31], v[64:67], v[76:79], v[16:31]
    v_mfma_f32_32x32x16_bf16 v[32:47], v[68:71], v[76:79], v[32:47]
    ds_read_b64_tr_b16 v[56:57], v8 offset:4096
    ds_read_b64_tr_b16 v[58:59], v8 offset:5120
    ds_read_b64_tr_b16 v[60:61], v9 offset:4096
    ds_read_b64_tr_b16 v[62:63], v9 offset:5120
    ds_read_b32 v12, v2 offset:32512
    s_waitcnt lgkmcnt(6)
    v_mfma_f32_32x32x16_bf16 v[16:31], v[48:51], v[80:83], v[16:31]
    v_mfma_f32_32x32x16_bf16 v[32:47], v[52:55], v[80:83], v[32:47]
    s_setprio 2
    s_waitcnt lgkmcnt(0)
    v_cmp_gt_i32 vcc, 11, v12
    s_cbranch_vccnz L_cs_30
L_cg_31:
    s_setprio 0
    ds_read_b64_tr_b16 v[64:65], v8 offset:8192
    ds_read_b64_tr_b16 v[66:67], v8 offset:9216
    ds_read_b64_tr_b16 v[68:69], v9 offset:8192
    ds_read_b64_tr_b16 v[70:71], v9 offset:9216
    ds_read_b64_tr_b16 v[192:193], v6 offset:0
    ds_read_b64_tr_b16 v[194:195], v6 offset:1024
    ds_read_b64_tr_b16 v[196:197], v7 offset:0
    ds_read_b64_tr_b16 v[198:199], v7 offset:1024
    v_mfma_f32_32x32x16_bf16 v[16:31], v[56:59], v[84:87], v[16:31]
    v_mfma_f32_32x32x16_bf16 v[32:47], v[60:63], v[84:87], v[32:47]
    ds_read_b64_tr_b16 v[48:49], v8 offset:12288
    ds_read_b64_tr_b16 v[50:51], v8 offset:13312
    ds_read_b64_tr_b16 v[52:53], v9 offset:12288
    ds_read_b64_tr_b16 v[54:55], v9 offset:13312
    ds_read_b64_tr_b16 v[200:201], v6 offset:4096
    ds_read_b64_tr_b16 v[202:203], v6 offset:5120
    ds_read_b64_tr_b16 v[204:205], v7 offset:4096
    ds_read_b64_tr_b16 v[206:207], v7 offset:5120
    s_setprio 2
    s_waitcnt vmcnt(0)
    v_max3_u32 v13, v104, v108, v112
    v_max3_u32 v13, v13, v116, v120
    v_max3_u32 v13, v13, v124, v128
    v_max_u32 v13, v13, v132
    v_cmp_eq_u32 vcc, -1, v13
    s_cbranch_vccnz L_o1r
L_o1g:
    s_setprio 0
    ds_read_b64_tr_b16 v[188:189], v8 offset:16384
    ds_read_b64_tr_b16 v[190:191], v8 offset:17408
    ds_read_b64_tr_b16 v[184:185], v9 offset:16384
    ds_read_b64_tr_b16 v[186:187], v9 offset:17408
    ds_read_b64_tr_b16 v[180:181], v8 offset:20480
    ds_read_b64_tr_b16 v[182:183], v8 offset:21504
    ds_read_b64_tr_b16 v[176:177], v9 offset:20480
    ds_read_b64_tr_b16 v[178:179], v9 offset:21504
    ds_read_b64_tr_b16 v[172:173], v8 offset:24576
    ds_read_b64_tr_b16 v[174:175], v8 offset:25600
    ds_read_b64_tr_b16 v[168:169], v9 offset:24576
    ds_read_b64_tr_b16 v[170:171], v9 offset:25600
    ds_read_b64_tr_b16 v[100:101], v8 offset:28672
    ds_read_b64_tr_b16 v[102:103], v8 offset:29696
    ds_read_b64_tr_b16 v[96:97], v9 offset:28672
    ds_read_b64_tr_b16 v[98:99], v9 offset:29696
    ds_read_b64_tr_b16 v[92:93], v8 offset:32768
    ds_read_b64_tr_b16 v[94:95], v8 offset:33792
    ds_read_b64_tr_b16 v[88:89], v9 offset:32768
    ds_read_b64_tr_b16 v[90:91], v9 offset:33792
    ds_read_b64_tr_b16 v[84:85], v8 offset:36864
    ds_read_b64_tr_b16 v[86:87], v8 offset:37888
    ds_read_b64_tr_b16 v[80:81], v9 offset:36864
    ds_read_b64_tr_b16 v[82:83], v9 offset:37888
    s_setprio 2
    s_barrier
    buffer_load_dwordx4 v[136:139], v10, s[44:47], s36 offen offset:1024 sc1
    buffer_load_dwordx4 v[140:143], v10, s[44:47], s36 offen offset:3072 sc1
    s_waitcnt lgkmcnt(14)
    v_mfma_f32_32x32x16_bf16 v[16:31], v[64:67], v[104:107], v[16:31]
    s_lshr_b32 s74, s71, 1
    s_lshl_b32 s73, s71, 7
    s_add_u32 s73, s73, s74
    s_lshl_b32 s73, s73, 6
    v_mfma_f32_32x32x16_bf16 v[32:47], v[68:71], v[104:107], v[32:47]
    buffer_load_dwordx4 v[144:147], v10, s[44:47], s37 offen offset:1024 sc1
    ds_read_b64_tr_b16 v[208:209], v6 offset:8192
    ds_read_b64_tr_b16 v[210:211], v6 offset:9216
    ds_read_b64_tr_b16 v[212:213], v7 offset:8192
    ds_read_b64_tr_b16 v[214:215], v7 offset:9216
    v_mfma_f32_32x32x16_bf16 v[16:31], v[48:51], v[108:111], v[16:31]
    v_and_b32 v72, 31, v0
    v_bfe_u32 v76, v0, 0, 3
    v_lshrrev_b32 v77, 5, v0
    v_xor_b32 v76, v76, v77
    v_mfma_f32_32x32x16_bf16 v[32:47], v[52:55], v[108:111], v[32:47]
    buffer_load_dwordx4 v[148:151], v10, s[44:47], s37 offen offset:3072 sc1
    ds_read_b64_tr_b16 v[216:217], v6 offset:12288
    ds_read_b64_tr_b16 v[218:219], v6 offset:13312
    ds_read_b64_tr_b16 v[220:221], v7 offset:12288
    ds_read_b64_tr_b16 v[222:223], v7 offset:13312
    v_mfma_f32_32x32x16_bf16 v[16:31], v[188:191], v[112:115], v[16:31]
    v_lshlrev_b32 v76, 4, v76
    v_lshl_add_u32 v72, v72, 7, v76
    v_xor_b32 v72, s73, v72
    v_mfma_f32_32x32x16_bf16 v[32:47], v[184:187], v[112:115], v[32:47]
    buffer_load_dwordx4 v[152:155], v10, s[44:47], s38 offen offset:1024 sc1
    ds_read_b64_tr_b16 v[224:225], v6 offset:16384
    ds_read_b64_tr_b16 v[226:227], v6 offset:17408
    ds_read_b64_tr_b16 v[228:229], v7 offset:16384
    ds_read_b64_tr_b16 v[230:231], v7 offset:17408
    v_mfma_f32_32x32x16_bf16 v[16:31], v[180:183], v[116:119], v[16:31]
    v_xor_b32 v73, 32, v72
    v_mfma_f32_32x32x16_bf16 v[32:47], v[176:179], v[116:119], v[32:47]
    buffer_load_dwordx4 v[156:159], v10, s[44:47], s38 offen offset:3072 sc1
    ds_read_b64_tr_b16 v[232:233], v6 offset:20480
    ds_read_b64_tr_b16 v[234:235], v6 offset:21504
    ds_read_b64_tr_b16 v[236:237], v7 offset:20480
    ds_read_b64_tr_b16 v[238:239], v7 offset:21504
    s_waitcnt lgkmcnt(14)
    v_mfma_f32_32x32x16_bf16 v[16:31], v[172:175], v[120:123], v[16:31]
    v_xor_b32 v74, 64, v72
    v_mfma_f32_32x32x16_bf16 v[32:47], v[168:171], v[120:123], v[32:47]
    buffer_load_dwordx4 v[160:163], v10, s[44:47], s39 offen offset:1024 sc1
    ds_read_b64_tr_b16 v[240:241], v6 offset:24576
    ds_read_b64_tr_b16 v[242:243], v6 offset:25600
    ds_read_b64_tr_b16 v[244:245], v7 offset:24576
    ds_read_b64_tr_b16 v[246:247], v7 offset:25600
    v_mfma_f32_32x32x16_bf16 v[16:31], v[100:103], v[124:127], v[16:31]
    v_xor_b32 v75, 96, v72
    v_mfma_f32_32x32x16_bf16 v[32:47], v[96:99], v[124:127], v[32:47]
    buffer_load_dwordx4 v[164:167], v10, s[44:47], s39 offen offset:3072 sc1
    ds_read_b64_tr_b16 v[248:249], v6 offset:28672
    ds_read_b64_tr_b16 v[250:251], v6 offset:29696
    ds_read_b64_tr_b16 v[252:253], v7 offset:28672
    ds_read_b64_tr_b16 v[254:255], v7 offset:29696
    v_mfma_f32_32x32x16_bf16 v[16:31], v[92:95], v[128:131], v[16:31]
    s_and_b32 s73, s71, 1
    s_lshl2_add_u32 s73, s73, s74
    s_lshl_b32 s73, s73, 11
    v_mfma_f32_32x32x16_bf16 v[32:47], v[88:91], v[128:131], v[32:47]
    v_lshrrev_b32 v3, 3, v0
    v_lshlrev_b32 v4, 4, v3
    v_xad_u32 v4, v4, v10, s73
    v_mfma_f32_32x32x16_bf16 v[16:31], v[84:87], v[132:135], v[16:31]
    v_mul_u32_u24 v3, 896, v3
    v_add_u32 v3, v3, v10
    v_mfma_f32_32x32x16_bf16 v[32:47], v[80:83], v[132:135], v[32:47]
    s_mov_b32 s31, 200000
    s_waitcnt lgkmcnt(0)
L_o2c0:
    s_waitcnt vmcnt(6)
    v_max_u32 v12, v136, v140
    v_cmp_eq_u32 vcc, -1, v12
    s_cbranch_vccnz L_o2r0
L_o2g0:
    v_mfma_f32_32x32x16_bf16 v[32:47], v[196:199], v[136:139], v[32:47]
    v_mfma_f32_32x32x16_bf16 v[32:47], v[204:207], v[140:143], v[32:47]
    v_mfma_f32_32x32x16_bf16 v[16:31], v[192:195], v[136:139], v[16:31]
    v_mfma_f32_32x32x16_bf16 v[16:31], v[200:203], v[140:143], v[16:31]
L_o2c1:
    s_waitcnt vmcnt(4)
    v_max_u32 v12, v144, v148
    v_cmp_eq_u32 vcc, -1, v12
    s_cbranch_vccnz L_o2r1
L_o2g1:
    v_mfma_f32_32x32x16_bf16 v[32:47], v[212:215], v[144:147], v[32:47]
    v_mfma_f32_32x32x16_bf16 v[32:47], v[220:223], v[148:151], v[32:47]
    v_mfma_f32_32x32x16_bf16 v[16:31], v[208:211], v[144:147], v[16:31]
    v_mfma_f32_32x32x16_bf16 v[16:31], v[216:219], v[148:151], v[16:31]
L_o2c2:
    s_waitcnt vmcnt(2)
    v_max_u32 v12, v152, v156
    v_cmp_eq_u32 vcc, -1, v12
    s_cbranch_vccnz L_o2r2
L_o2g2:
    v_mfma_f32_32x32x16_bf16 v[32:47], v[228:231], v[152:155], v[32:47]
    v_mfma_f32_32x32x16_bf16 v[32:47], v[236:239], v[156:159], v[32:47]
    v_mfma_f32_32x32x16_bf16 v[16:31], v[224:227], v[152:155], v[16:31]
    v_mfma_f32_32x32x16_bf16 v[16:31], v[232:235], v[156:159], v[16:31]
L_o2c3:
    s_waitcnt vmcnt(0)
    v_max_u32 v12, v160, v164
    v_cmp_eq_u32 vcc, -1, v12
    s_cbranch_vccnz L_o2r3
L_o2g3:
    v_mfma_f32_32x32x16_bf16 v[32:47], v[244:247], v[160:163], v[32:47]
    v_mfma_f32_32x32x16_bf16 v[32:47], v[252:255], v[164:167], v[32:47]
    v_mfma_f32_32x32x16_bf16 v[16:31], v[240:243], v[160:163], v[16:31]
    v_mfma_f32_32x32x16_bf16 v[16:31], v[248:251], v[164:167], v[16:31]
    s_nop 9
    ds_write_b128 v74, v[32:35] offset:0
    ds_write_b128 v74, v[36:39] offset:4096
    ds_write_b128 v75, v[40:43] offset:0
    ds_write_b128 v75, v[44:47] offset:4096
    ds_write_b128 v72, v[16:19] offset:0
    ds_write_b128 v72, v[20:23] offset:4096
    ds_write_b128 v73, v[24:27] offset:0
    ds_write_b128 v73, v[28:31] offset:4096
    s_waitcnt lgkmcnt(0)
    s_barrier
    ds_read_b128 v[16:19], v4 offset:0
    ds_read_b128 v[34:37], v4 offset:16384
    ds_read_b128 v[20:23], v4 offset:4096
    ds_read_b128 v[38:41], v4 offset:20480
    ds_read_b128 v[24:27], v4 offset:1024
    ds_read_b128 v[42:45], v4 offset:17408
    ds_read_b128 v[28:31], v4 offset:5120
    ds_read_b128 v[46:49], v4 offset:21504
    s_waitcnt lgkmcnt(6)
    v_pk_add_f32 v[16:17], v[16:17], v[34:35]
    v_pk_add_f32 v[18:19], v[18:19], v[36:37]
    s_waitcnt lgkmcnt(4)
    v_pk_add_f32 v[20:21], v[20:21], v[38:39]
    v_pk_add_f32 v[22:23], v[22:23], v[40:41]
    v_cvt_pk_bf16_f32 v52, v16, v17
    v_cvt_pk_bf16_f32 v53, v18, v19
    v_cvt_pk_bf16_f32 v54, v20, v21
    v_cvt_pk_bf16_f32 v55, v22, v23
    buffer_store_dwordx4 v[52:55], v3, s[60:63], s77 offen nt
    s_waitcnt lgkmcnt(2)
    v_pk_add_f32 v[24:25], v[24:25], v[42:43]
    v_pk_add_f32 v[26:27], v[26:27], v[44:45]
    s_waitcnt lgkmcnt(0)
    v_pk_add_f32 v[28:29], v[28:29], v[46:47]
    v_pk_add_f32 v[30:31], v[30:31], v[48:49]
    v_cvt_pk_bf16_f32 v56, v24, v25
    v_cvt_pk_bf16_f32 v57, v26, v27
    v_cvt_pk_bf16_f32 v58, v28, v29
    v_cvt_pk_bf16_f32 v59, v30, v31
    buffer_store_dwordx4 v[56:59], v3, s[60:63], s78 offen nt
L_end:
L_last:
    s_endpgm
L_o2r0:
    buffer_load_dwordx4 v[136:139], v10, s[44:47], s36 offen offset:1024 sc1
    buffer_load_dwordx4 v[140:143], v10, s[44:47], s36 offen offset:3072 sc1
    s_waitcnt vmcnt(2)
    v_max_u32 v12, v144, v148
    v_cmp_eq_u32 vcc, -1, v12
    s_cbranch_vccz L_o2s02
    buffer_load_dwordx4 v[144:147], v10, s[44:47], s37 offen offset:1024 sc1
    buffer_load_dwordx4 v[148:151], v10, s[44:47], s37 offen offset:3072 sc1
L_o2s02:
    v_max_u32 v12, v152, v156
    v_cmp_eq_u32 vcc, -1, v12
    s_cbranch_vccz L_o2s04
    buffer_load_dwordx4 v[152:155], v10, s[44:47], s38 offen offset:1024 sc1
    buffer_load_dwordx4 v[156:159], v10, s[44:47], s38 offen offset:3072 sc1
L_o2s04:
    v_max_u32 v12, v160, v164
    v_cmp_eq_u32 vcc, -1, v12
    s_cbranch_vccz L_o2s06
    buffer_load_dwordx4 v[160:163], v10, s[44:47], s39 offen offset:1024 sc1
    buffer_load_dwordx4 v[164:167], v10, s[44:47], s39 offen offset:3072 sc1
L_o2s06:
L_o2w0:
    s_sub_u32 s31, s31, 1
    s_waitcnt vmcnt(0)
    s_cbranch_scc1 L_o2x0
    v_max_u32 v12, v136, v140
    v_cmp_eq_u32 vcc, -1, v12
    s_cbranch_vccz L_o2g0
    s_branch L_o2r0
L_o2x0:
    s_mov_b32 s31, 0
    s_branch L_o2g0
L_o2r1:
    buffer_load_dwordx4 v[144:147], v10, s[44:47], s37 offen offset:1024 sc1
    buffer_load_dwordx4 v[148:151], v10, s[44:47], s37 offen offset:3072 sc1
    s_waitcnt vmcnt(2)
    v_max_u32 v12, v152, v156
    v_cmp_eq_u32 vcc, -1, v12
    s_cbranch_vccz L_o2s14
    buffer_load_dwordx4 v[152:155], v10, s[44:47], s38 offen offset:1024 sc1
    buffer_load_dwordx4 v[156:159], v10, s[44:47], s38 offen offset:3072 sc1
L_o2s14:
    v_max_u32 v12, v160, v164
    v_cmp_eq_u32 vcc, -1, v12
    s_cbranch_vccz L_o2s16
    buffer_load_dwordx4 v[160:163], v10, s[44:47], s39 offen offset:1024 sc1
    buffer_load_dwordx4 v[164:167], v10, s[44:47], s39 offen offset:3072 sc1
L_o2s16:
L_o2w1:
    s_sub_u32 s31, s31, 1
    s_waitcnt vmcnt(0)
    s_cbranch_scc1 L_o2x1
    v_max_u32 v12, v144, v148
    v_cmp_eq_u32 vcc, -1, v12
    s_cbranch_vccz L_o2g1
    s_branch L_o2r1
L_o2x1:
    s_mov_b32 s31, 0
    s_branch L_o2g1
L_o2r2:
    buffer_load_dwordx4 v[152:155], v10, s[44:47], s38 offen offset:1024 sc1
    buffer_load_dwordx4 v[156:159], v10, s[44:47], s38 offen offset:3072 sc1
    s_waitcnt vmcnt(2)
    v_max_u32 v12, v160, v164
    v_cmp_eq_u32 vcc, -1, v12
    s_cbranch_vccz L_o2s26
    buffer_load_dwordx4 v[160:163], v10, s[44:47], s39 offen offset:1024 sc1
    buffer_load_dwordx4 v[164:167], v10, s[44:47], s39 offen offset:3072 sc1
L_o2s26:
L_o2w2:
    s_sub_u32 s31, s31, 1
    s_waitcnt vmcnt(0)
    s_cbranch_scc1 L_o2x2
    v_max_u32 v12, v152, v156
    v_cmp_eq_u32 vcc, -1, v12
    s_cbranch_vccz L_o2g2
    s_branch L_o2r2
L_o2x2:
    s_mov_b32 s31, 0
    s_branch L_o2g2
L_o2r3:
    buffer_load_dwordx4 v[160:163], v10, s[44:47], s39 offen offset:1024 sc1
    buffer_load_dwordx4 v[164:167], v10, s[44:47], s39 offen offset:3072 sc1
    s_waitcnt vmcnt(2)
L_o2w3:
    s_sub_u32 s31, s31, 1
    s_waitcnt vmcnt(0)
    s_cbranch_scc1 L_o2x3
    v_max_u32 v12, v160, v164
    v_cmp_eq_u32 vcc, -1, v12
    s_cbranch_vccz L_o2g3
    s_branch L_o2r3
L_o2x3:
    s_mov_b32 s31, 0
    s_branch L_o2g3
L_light:
    s_lshl2_add_u32 s88, s68, s71
    s_lshl3_add_u32 s88, s88, s69
    s_lshl_b32 s88, s88, 11
    s_add_u32 s88, s88, 589824
    s_cmp_gt_u32 s83, 28
    s_cselect_b32 s75, 0, 184320
    s_mul_i32 s73, s68, 184320
    s_add_u32 s73, s73, 2686976
    s_add_u32 s48, s28, s73
    s_addc_u32 s49, s29, 0
    s_mov_b32 s50, s75
    s_mov_b32 s51, 0x20000
    s_mov_b32 s96, 0xbfb8aa3b
    s_mov_b32 s97, s96
    s_lshr_b32 s75, s71, 1
    s_lshl_b32 s73, s75, 15
    s_sub_u32 s74, 1409024, s73
    s_add_u32 s52, s20, s73
    s_addc_u32 s53, s21, 0
    s_mov_b32 s54, s74
    s_mov_b32 s55, 0x20000
    s_lshl_b32 s73, s75, 14
    s_sub_u32 s74, 524288, s73
    s_add_u32 s56, s12, s73
    s_addc_u32 s57, s13, 0
    s_mov_b32 s58, s74
    s_mov_b32 s59, 0x20000
    s_lshl_b32 s79, s75, 30
    s_and_b32 s73, s83, 1
    s_mul_i32 s73, s73, 91648
    s_lshl_b32 s74, s83, 9
    s_add_u32 s90, s73, s74
    s_lshl_b32 s85, s71, 10
    s_add_u32 s85, s85, 57344
    s_mov_b32 s31, 200000
L_lw_32:
    ds_read_b32 v12, v11 offset:32256
    s_waitcnt lgkmcnt(0)
    v_cmp_gt_i32 vcc, 3, v12
    s_cbranch_vccz L_ok_33
    s_sleep 4
    s_sub_u32 s31, s31, 1
    s_cmp_lg_u32 s31, 0
    s_cbranch_scc1 L_lw_32
L_ok_33:
    s_mul_i32 s73, s68, 3
    s_add_u32 s73, s73, s71
    s_sub_u32 s73, s73, 1
    s_lshl_b32 s73, s73, 13
    v_lshlrev_b32 v236, 7, v0
    s_mov_b64 s[36:37], s[20:21]
    s_mov_b32 s38, 1409024
    s_mov_b32 s39, 0x20000
    s_mov_b64 s[40:41], s[12:13]
    s_mov_b32 s42, 524288
    s_mov_b32 s43, 0x20000
    s_add_u32 s74, s73, 0
    buffer_load_dword v237, v236, s[36:39], s74 offen offset:0
    s_waitcnt vmcnt(0)
    s_add_u32 s74, s73, 786432
    buffer_load_dword v237, v236, s[36:39], s74 offen offset:0
    s_waitcnt vmcnt(0)
    s_add_u32 s74, s73, 0
    buffer_load_dword v237, v236, s[40:43], s74 offen offset:0
    s_waitcnt vmcnt(0)
    buffer_store_dwordx4 v[192:195], v10, s[44:47], s88 offen offset:0 sc1
    buffer_store_dwordx4 v[192:195], v10, s[44:47], s88 offen offset:1024 sc1
    s_lshl_b32 s73, s83, 5
    s_add_u32 s95, s95, s73
    s_mul_i32 s74, s71, 46080
    s_add_u32 s64, s48, s74
    s_addc_u32 s65, s49, 0
    s_mov_b32 s66, 46080
    s_mov_b32 s67, 0x20000
    s_mov_b64 s[60:61], s[24:25]
    s_mov_b32 s62, 2097152
    s_mov_b32 s63, 0x20000
    s_mov_b64 s[40:41], s[28:29]
    s_mov_b32 s42, 0
    s_mov_b32 s43, 0x20000
    s_lshl_b32 s73, s68, 16
    s_lshl_b32 s74, s71, 14
    s_add_u32 s74, s73, s74
    s_add_u32 s36, s74, 589824
    s_add_u32 s37, s74, 593920
    s_add_u32 s38, s74, 598016
    s_add_u32 s39, s74, 602112
    s_and_b32 s74, s71, 1
    s_lshl_b32 s74, s74, 15
    s_add_u32 s73, s73, s74
    s_lshl_b32 s74, s69, 7
    s_add_u32 s73, s73, s74
    s_lshr_b32 s74, s71, 1
    s_lshl_b32 s74, s74, 14
    s_add_u32 s77, s73, s74
    s_add_u32 s78, s77, 8192
    buffer_load_dword v196, v216, s[44:47], 0 offen sc1
    buffer_load_dword v196, v216, s[44:47], 0 offen offset:128 sc1
    s_branch L_Bh
L_o1r:
    s_mov_b32 s31, 200000
    s_lshl_b32 s73, s71, 8
    v_add_u32 v14, s73, v11
L_r1wait:
    ds_read_b32 v13, v14 offset:27904
    s_waitcnt lgkmcnt(0)
    v_cmp_eq_u32 vcc, -1, v13
    s_cbranch_vccz L_ok_34
    s_sleep 2
    s_sub_u32 s31, s31, 1
    s_cmp_lg_u32 s31, 0
    s_cbranch_scc1 L_r1wait
L_ok_34:
    s_mov_b32 s31, 200000
L_o1l:
    buffer_load_dwordx4 v[104:107], v10, s[44:47], s36 offen offset:0 sc1
    buffer_load_dwordx4 v[108:111], v10, s[44:47], s36 offen offset:2048 sc1
    buffer_load_dwordx4 v[112:115], v10, s[44:47], s37 offen offset:0 sc1
    buffer_load_dwordx4 v[116:119], v10, s[44:47], s37 offen offset:2048 sc1
    buffer_load_dwordx4 v[120:123], v10, s[44:47], s38 offen offset:0 sc1
    buffer_load_dwordx4 v[124:127], v10, s[44:47], s38 offen offset:2048 sc1
    buffer_load_dwordx4 v[128:131], v10, s[44:47], s39 offen offset:0 sc1
    buffer_load_dwordx4 v[132:135], v10, s[44:47], s39 offen offset:2048 sc1
    s_waitcnt vmcnt(0)
    v_max3_u32 v13, v104, v108, v112
    v_max3_u32 v13, v13, v116, v120
    v_max3_u32 v13, v13, v124, v128
    v_max_u32 v13, v13, v132
    v_cmp_eq_u32 vcc, -1, v13
    s_cbranch_vccz L_ok_35
    s_sleep 3
    s_sub_u32 s31, s31, 1
    s_cmp_lg_u32 s31, 0
    s_cbranch_scc1 L_o1l
L_ok_35:
    s_branch L_o1g
L_hretry:
    s_mov_b32 s31, 200000
L_hretryl:
    buffer_load_dword v201, v216, s[44:47], 0 offen offset:128 sc1
    s_waitcnt vmcnt(0)
    v_cmp_ne_u32 vcc, s30, v201
    s_cbranch_vccz L_ok_36
    s_sleep 2
    s_sub_u32 s31, s31, 1
    s_cmp_lg_u32 s31, 0
    s_cbranch_scc1 L_hretryl
L_ok_36:
    s_branch L_hgot
L_hfar:
    s_waitcnt vmcnt(0)
    s_mov_b64 exec, 1
    buffer_store_dword v230, off, s[44:47], s82 offset:0
    buffer_store_dword v230, off, s[44:47], s95 sc1
    s_mov_b64 exec, -1
    s_mov_b32 s31, 200000
L_hfarl:
    buffer_load_dword v201, v232, s[44:47], 0 offen offset:0 sc1
    s_waitcnt vmcnt(0)
    v_cmp_ne_u32 vcc, s30, v201
    s_cbranch_vccz L_ok_37
    s_sleep 2
    s_sub_u32 s31, s31, 1
    s_cmp_lg_u32 s31, 0
    s_cbranch_scc1 L_hfarl
L_ok_37:
    s_branch L_hgot
L_h2retry:
    s_mov_b32 s31, 200000
L_h2retryl:
    buffer_load_dword v201, v232, s[44:47], 0 offen offset:0 sc1
    s_waitcnt vmcnt(0)
    v_cmp_ne_u32 vcc, s30, v201
    s_cbranch_vccz L_ok_38
    s_sleep 2
    s_sub_u32 s31, s31, 1
    s_cmp_lg_u32 s31, 0
    s_cbranch_scc1 L_h2retryl
L_ok_38:
    s_branch L_h2got
L_cretry:
    s_mov_b32 s31, 200000
L_cretryl:
    ds_read_b32 v12, v11 offset:32512
    ds_read2_b32 v[218:219], v13 offset1:32
    s_waitcnt lgkmcnt(0)
    v_cmp_gt_i32 vcc, 1, v12
    s_cbranch_vccz L_ok_39
    s_sleep 1
    s_sub_u32 s31, s31, 1
    s_cmp_lg_u32 s31, 0
    s_cbranch_scc1 L_cretryl
L_ok_39:
    s_branch L_cgot
L_cs_16:
    s_mov_b32 s31, 200000
L_lw_40:
    ds_read_b32 v12, v2 offset:32512
    s_waitcnt lgkmcnt(0)
    v_cmp_gt_i32 vcc, 4, v12
    s_cbranch_vccz L_ok_41
    s_sleep 1
    s_sub_u32 s31, s31, 1
    s_cmp_lg_u32 s31, 0
    s_cbranch_scc1 L_lw_40
L_ok_41:
    s_branch L_cg_17
L_cs_18:
    s_mov_b32 s31, 200000
L_lw_42:
    ds_read_b32 v12, v2 offset:32512
    s_waitcnt lgkmcnt(0)
    v_cmp_gt_i32 vcc, 5, v12
    s_cbranch_vccz L_ok_43
    s_sleep 1
    s_sub_u32 s31, s31, 1
    s_cmp_lg_u32 s31, 0
    s_cbranch_scc1 L_lw_42
L_ok_43:
    s_branch L_cg_19
L_cs_20:
    s_mov_b32 s31, 200000
L_lw_44:
    ds_read_b32 v12, v2 offset:32512
    s_waitcnt lgkmcnt(0)
    v_cmp_gt_i32 vcc, 6, v12
    s_cbranch_vccz L_ok_45
    s_sleep 1
    s_sub_u32 s31, s31, 1
    s_cmp_lg_u32 s31, 0
    s_cbranch_scc1 L_lw_44
L_ok_45:
    s_branch L_cg_21
L_cs_22:
    s_mov_b32 s31, 200000
L_lw_46:
    ds_read_b32 v12, v2 offset:32512
    s_waitcnt lgkmcnt(0)
    v_cmp_gt_i32 vcc, 7, v12
    s_cbranch_vccz L_ok_47
    s_sleep 1
    s_sub_u32 s31, s31, 1
    s_cmp_lg_u32 s31, 0
    s_cbranch_scc1 L_lw_46
L_ok_47:
    s_branch L_cg_23
L_cs_24:
    s_mov_b32 s31, 200000
L_lw_48:
    ds_read_b32 v12, v2 offset:32512
    s_waitcnt lgkmcnt(0)
    v_cmp_gt_i32 vcc, 8, v12
    s_cbranch_vccz L_ok_49
    s_sleep 1
    s_sub_u32 s31, s31, 1
    s_cmp_lg_u32 s31, 0
    s_cbranch_scc1 L_lw_48
L_ok_49:
    s_branch L_cg_25
L_cs_26:
    s_mov_b32 s31, 200000
L_lw_50:
    ds_read_b32 v12, v2 offset:32512
    s_waitcnt lgkmcnt(0)
    v_cmp_gt_i32 vcc, 9, v12
    s_cbranch_vccz L_ok_51
    s_sleep 1
    s_sub_u32 s31, s31, 1
    s_cmp_lg_u32 s31, 0
    s_cbranch_scc1 L_lw_50
L_ok_51:
    s_branch L_cg_27
L_cs_28:
    s_mov_b32 s31, 200000
L_lw_52:
    ds_read_b32 v12, v2 offset:32512
    s_waitcnt lgkmcnt(0)
    v_cmp_gt_i32 vcc, 10, v12
    s_cbranch_vccz L_ok_53
    s_sleep 1
    s_sub_u32 s31, s31, 1
    s_cmp_lg_u32 s31, 0
    s_cbranch_scc1 L_lw_52
L_ok_53:
    s_branch L_cg_29
L_cs_30:
    s_mov_b32 s31, 200000
L_lw_54:
    ds_read_b32 v12, v2 offset:32512
    s_waitcnt lgkmcnt(0)
    v_cmp_gt_i32 vcc, 11, v12
    s_cbranch_vccz L_ok_55
    s_sleep 1
    s_sub_u32 s31, s31, 1
    s_cmp_lg_u32 s31, 0
    s_cbranch_scc1 L_lw_54
L_ok_55:
    s_branch L_cg_31
L_slow0:
    v_lshlrev_b32 v157, 4, v0
    v_lshrrev_b32 v158, 5, v0
    v_lshlrev_b32 v158, 8, v158
    v_and_b32 v159, 15, v0
    v_lshl_add_u32 v158, v159, 4, v158
    v_mov_b32 v156, 0xff800000
    v_mov_b32 v132, 0x3f803f80
    v_mov_b32 v133, 0x3f803f80
    v_mov_b32 v134, 0x3f803f80
    v_mov_b32 v135, 0x3f803f80
    v_mov_b32 v136, 0x3f803f80
    v_mov_b32 v137, 0x3f803f80
    v_mov_b32 v138, 0x3f803f80
    v_mov_b32 v139, 0x3f803f80
    v_mov_b32 v176, 0
    v_mov_b32 v177, 0
    v_mov_b32 v178, 0
    v_mov_b32 v179, 0
    v_mov_b32 v180, 0
    v_mov_b32 v181, 0
    v_mov_b32 v182, 0
    v_mov_b32 v183, 0
    v_mov_b32 v184, 0
    v_mov_b32 v185, 0
    v_mov_b32 v186, 0
    v_mov_b32 v187, 0
    v_mov_b32 v188, 0
    v_mov_b32 v189, 0
    v_mov_b32 v190, 0
    v_mov_b32 v191, 0
    s_mov_b32 s77, 65536
L_sm_56:
    buffer_load_dwordx4 v[128:131], v157, s[44:47], s77 offen sc1
    s_waitcnt vmcnt(0)
    v_mfma_f32_32x32x16_bf16 v[140:155], v[128:131], v[108:111], 0
    s_nop 15
    v_max3_f32 v156, v156, v140, v141
    v_max3_f32 v156, v156, v142, v143
    v_max3_f32 v156, v156, v144, v145
    v_max3_f32 v156, v156, v146, v147
    v_max3_f32 v156, v156, v148, v149
    v_max3_f32 v156, v156, v150, v151
    v_max3_f32 v156, v156, v152, v153
    v_max3_f32 v156, v156, v154, v155
    s_add_u32 s77, s77, 2048
    s_cmp_lt_u32 s77, 196608
    s_cbranch_scc1 L_sm_56
    v_mov_b32 v159, v156
    s_nop 1
    v_permlane32_swap_b32 v159, v156
    s_nop 1
    v_max_f32 v156, v156, v159
    s_mov_b32 s77, 65536
L_sp_57:
    buffer_load_dwordx4 v[128:131], v157, s[44:47], s77 offen sc1
    s_mov_b64 exec, s[96:97]
    buffer_load_dwordx4 v[132:135], v158, s[44:47], s77 offen offset:1024 sc1
    buffer_load_dwordx4 v[136:139], v158, s[44:47], s77 offen offset:1536 sc1
    s_mov_b64 exec, -1
    s_waitcnt vmcnt(0)
    v_mfma_f32_32x32x16_bf16 v[140:155], v[128:131], v[108:111], 0
    s_nop 15
    v_sub_f32 v140, v140, v156
    v_sub_f32 v141, v141, v156
    v_sub_f32 v142, v142, v156
    v_sub_f32 v143, v143, v156
    v_sub_f32 v144, v144, v156
    v_sub_f32 v145, v145, v156
    v_sub_f32 v146, v146, v156
    v_sub_f32 v147, v147, v156
    v_sub_f32 v148, v148, v156
    v_sub_f32 v149, v149, v156
    v_sub_f32 v150, v150, v156
    v_sub_f32 v151, v151, v156
    v_sub_f32 v152, v152, v156
    v_sub_f32 v153, v153, v156
    v_sub_f32 v154, v154, v156
    v_sub_f32 v155, v155, v156
    v_exp_f32 v140, v140
    v_exp_f32 v141, v141
    v_exp_f32 v142, v142
    v_exp_f32 v143, v143
    v_exp_f32 v144, v144
    v_exp_f32 v145, v145
    v_exp_f32 v146, v146
    v_exp_f32 v147, v147
    v_exp_f32 v148, v148
    v_exp_f32 v149, v149
    v_exp_f32 v150, v150
    v_exp_f32 v151, v151
    v_exp_f32 v152, v152
    v_exp_f32 v153, v153
    v_exp_f32 v154, v154
    v_exp_f32 v155, v155
    s_nop 1
    v_smfmac_f32_32x32x32_bf16 v[176:191], v[132:135], v[140:147], v1
    v_smfmac_f32_32x32x32_bf16 v[176:191], v[136:139], v[148:155], v1
    s_add_u32 s77, s77, 2048
    s_cmp_lt_u32 s77, 196608
    s_cbranch_scc1 L_sp_57
    s_nop 15
    s_branch L_slowed0
L_slow1:
    v_lshlrev_b32 v221, 4, v0
    v_lshrrev_b32 v222, 5, v0
    v_lshlrev_b32 v222, 8, v222
    v_and_b32 v223, 15, v0
    v_lshl_add_u32 v222, v223, 4, v222
    v_mov_b32 v220, 0xff800000
    v_mov_b32 v196, 0x3f803f80
    v_mov_b32 v197, 0x3f803f80
    v_mov_b32 v198, 0x3f803f80
    v_mov_b32 v199, 0x3f803f80
    v_mov_b32 v200, 0x3f803f80
    v_mov_b32 v201, 0x3f803f80
    v_mov_b32 v202, 0x3f803f80
    v_mov_b32 v203, 0x3f803f80
    v_mov_b32 v240, 0
    v_mov_b32 v241, 0
    v_mov_b32 v242, 0
    v_mov_b32 v243, 0
    v_mov_b32 v244, 0
    v_mov_b32 v245, 0
    v_mov_b32 v246, 0
    v_mov_b32 v247, 0
    v_mov_b32 v248, 0
    v_mov_b32 v249, 0
    v_mov_b32 v250, 0
    v_mov_b32 v251, 0
    v_mov_b32 v252, 0
    v_mov_b32 v253, 0
    v_mov_b32 v254, 0
    v_mov_b32 v255, 0
    s_mov_b32 s77, 65536
L_sm_58:
    buffer_load_dwordx4 v[192:195], v221, s[44:47], s77 offen sc1
    s_waitcnt vmcnt(0)
    v_mfma_f32_32x32x16_bf16 v[204:219], v[192:195], v[124:127], 0
    s_nop 15
    v_max3_f32 v220, v220, v204, v205
    v_max3_f32 v220, v220, v206, v207
    v_max3_f32 v220, v220, v208, v209
    v_max3_f32 v220, v220, v210, v211
    v_max3_f32 v220, v220, v212, v213
    v_max3_f32 v220, v220, v214, v215
    v_max3_f32 v220, v220, v216, v217
    v_max3_f32 v220, v220, v218, v219
    s_add_u32 s77, s77, 2048
    s_cmp_lt_u32 s77, 196608
    s_cbranch_scc1 L_sm_58
    v_mov_b32 v223, v220
    s_nop 1
    v_permlane32_swap_b32 v223, v220
    s_nop 1
    v_max_f32 v220, v220, v223
    s_mov_b32 s77, 65536
L_sp_59:
    buffer_load_dwordx4 v[192:195], v221, s[44:47], s77 offen sc1
    s_mov_b64 exec, s[96:97]
    buffer_load_dwordx4 v[196:199], v222, s[44:47], s77 offen offset:1024 sc1
    buffer_load_dwordx4 v[200:203], v222, s[44:47], s77 offen offset:1536 sc1
    s_mov_b64 exec, -1
    s_waitcnt vmcnt(0)
    v_mfma_f32_32x32x16_bf16 v[204:219], v[192:195], v[124:127], 0
    s_nop 15
    v_sub_f32 v204, v204, v220
    v_sub_f32 v205, v205, v220
    v_sub_f32 v206, v206, v220
    v_sub_f32 v207, v207, v220
    v_sub_f32 v208, v208, v220
    v_sub_f32 v209, v209, v220
    v_sub_f32 v210, v210, v220
    v_sub_f32 v211, v211, v220
    v_sub_f32 v212, v212, v220
    v_sub_f32 v213, v213, v220
    v_sub_f32 v214, v214, v220
    v_sub_f32 v215, v215, v220
    v_sub_f32 v216, v216, v220
    v_sub_f32 v217, v217, v220
    v_sub_f32 v218, v218, v220
    v_sub_f32 v219, v219, v220
    v_exp_f32 v204, v204
    v_exp_f32 v205, v205
    v_exp_f32 v206, v206
    v_exp_f32 v207, v207
    v_exp_f32 v208, v208
    v_exp_f32 v209, v209
    v_exp_f32 v210, v210
    v_exp_f32 v211, v211
    v_exp_f32 v212, v212
    v_exp_f32 v213, v213
    v_exp_f32 v214, v214
    v_exp_f32 v215, v215
    v_exp_f32 v216, v216
    v_exp_f32 v217, v217
    v_exp_f32 v218, v218
    v_exp_f32 v219, v219
    s_nop 1
    v_smfmac_f32_32x32x32_bf16 v[240:255], v[196:199], v[204:211], v1
    v_smfmac_f32_32x32x32_bf16 v[240:255], v[200:203], v[212:219], v1
    s_add_u32 s77, s77, 2048
    s_cmp_lt_u32 s77, 196608
    s_cbranch_scc1 L_sp_59
    s_nop 15
    s_branch L_slowed1
.section .rodata,"a"
.p2align 6
.amdhsa_kernel gated_mix__grouped_kv_mqa__glu_gated_swiglu__prompt_kernel
  .amdhsa_next_free_vgpr 256
  .amdhsa_next_free_sgpr 102
  .amdhsa_accum_offset 256
  .amdhsa_group_segment_fixed_size 0
  .amdhsa_kernarg_size 104
  .amdhsa_user_sgpr_count 2
  .amdhsa_user_sgpr_kernarg_segment_ptr 1
  .amdhsa_system_sgpr_workgroup_id_x 1
  .amdhsa_float_denorm_mode_32 3
.end_amdhsa_kernel
```
